```python
import torch

def _softmax(x, axis=-1):
    return torch.softmax(x, dim=axis)

def _gelu(x):
    return torch.nn.functional.gelu(x, approximate='tanh')

def _silu(x):
    return torch.nn.functional.silu(x)

def _sigmoid(x):
    return torch.sigmoid(x)

def _layernorm(x, axis=-1, eps=1e-05):
    m = x.mean(dim=axis, keepdim=True)
    v = x.var(dim=axis, keepdim=True, unbiased=False)
    return (x - m) / torch.sqrt(v + eps)

def _scatter_add(tgt, idx, src, axis=0):
    return tgt.clone().index_add_(axis, idx, src)

def _segment_sum(src, seg, n):
    out = torch.zeros((n,) + src.shape[1:], dtype=src.dtype)
    return out.index_add_(0, seg, src)

def _pad(x, pw):
    flat = tuple((v for pair in reversed(pw) for v in pair))
    return torch.nn.functional.pad(x, flat)
kernel_name = 'adaLN_cond__linear_kernel_hedgehog__glu_gated_reglu__prompt'

def setup_inputs():

    _w = lambda a: (lambda t: t.to(torch.bfloat16) if t.is_floating_point() else t)(torch.as_tensor(a))

    def _A_setup():
        B, S, D, H = (1, 2048, 512, 32)
        Dh = D // H
        return {'x': _w((lambda *s: torch.randn(*s, dtype=torch.bfloat16) * 0.05)(B, S, D)), 'wqkv': _w((lambda *s: torch.randn(*s, dtype=torch.bfloat16) * 0.4)(D, 3 * D)), 'w_phi': _w((lambda *s: torch.randn(*s, dtype=torch.bfloat16) * 0.4)(H, Dh, Dh) * Dh ** (-0.5)), 'wo': _w((lambda *s: torch.randn(*s, dtype=torch.bfloat16) * 0.05)(D, D))}
    _A_in = _A_setup()

    def _B_setup():
        B, S, D, F = (1, 2048, 512, 1792)
        return {'x': _w((lambda *s: torch.randn(*s, dtype=torch.bfloat16) * 0.05)(B, S, D)), 'W_gate': _w((lambda *s: torch.randn(*s, dtype=torch.bfloat16) * 0.8)(D, F) * (2.0 / D) ** 0.5), 'W_up': _w((lambda *s: torch.randn(*s, dtype=torch.bfloat16) * 0.8)(D, F) * (2.0 / D) ** 0.5), 'W_down': _w((lambda *s: torch.randn(*s, dtype=torch.bfloat16) * 0.8)(F, D) * (1.0 / F) ** 0.5)}
    _B_in = _B_setup()
    return {'A_x': _A_in['x'], 'A_wqkv': _A_in['wqkv'], 'A_w_phi': _A_in['w_phi'], 'A_wo': _A_in['wo'], 'B_x': _B_in['x'], 'B_W_gate': _B_in['W_gate'], 'B_W_up': _B_in['W_up'], 'B_W_down': _B_in['W_down'], 'c': _w((lambda *s: torch.randn(*s, dtype=torch.bfloat16) * 0.2)(1, 512) * 8.0), 'w_mod': _w((lambda *s: torch.randn(*s, dtype=torch.bfloat16) * 0.2)(512, 6 * 512) * 512 ** (-0.5) * 8.0)}

def reference(A_x, A_wqkv, A_w_phi, A_wo, B_x, B_W_gate, B_W_up, B_W_down, c, w_mod):

    def _A_ref(x, wqkv, w_phi, wo):
        B, S, D = x.shape
        H = 32
        Dh = D // H
        qkv = (lambda x, *d: x.permute(*d))((x @ wqkv).reshape(B, S, 3, H, Dh), 2, 0, 3, 1, 4)
        q, k, v = (qkv[0], qkv[1], qkv[2])
        pq = torch.einsum('bhsd,hdf->bhsf', q, w_phi)
        pk = torch.einsum('bhsd,hdf->bhsf', k, w_phi)
        phi_q = torch.concatenate([_softmax(pq, axis=-1), _softmax(-pq, axis=-1)], axis=-1)
        phi_k = torch.concatenate([_softmax(pk, axis=-1), _softmax(-pk, axis=-1)], axis=-1)
        kv = torch.einsum('bhsf,bhsd->bhfd', phi_k, v)
        z = torch.einsum('bhsf->bhf', phi_k)
        num = torch.einsum('bhqf,bhfd->bhqd', phi_q, kv)
        den = torch.einsum('bhqf,bhf->bhq', phi_q, z)[..., None] + 1e-06
        o = num / den
        return (lambda x, *d: x.permute(*d))(o, 0, 2, 1, 3).reshape(B, S, D) @ wo

    def _B_ref(x, W_gate, W_up, W_down):
        gate = torch.einsum('bsd,df->bsf', x, W_gate)
        up = torch.einsum('bsd,df->bsf', x, W_up)
        gate = gate * (lambda x, dt: x.to(dt))(gate > 0, gate.dtype)
        h = gate * up
        return torch.einsum('bsf,fd->bsd', h, W_down)
    x = A_x
    mod = (_silu(c) @ w_mod).reshape(c.shape[0], 6, 1, -1)
    sa, ca, ga, sb, cb, gb = (mod[:, 0].clone(), mod[:, 1].clone(), mod[:, 2].clone(), mod[:, 3].clone(), mod[:, 4].clone(), mod[:, 5].clone())
    h = _layernorm(x, axis=-1) * (1 + ca) + sa
    x = x + ga * _A_ref(h, A_wqkv, A_w_phi, A_wo)
    h = _layernorm(x, axis=-1) * (1 + cb) + sb
    x = x + gb * _B_ref(h, B_W_gate, B_W_up, B_W_down)
    return x
```

```asm
; @launch grid=(256,1,1) block=(256,1,1) lds=163840
.amdgcn_target "amdgcn-amd-amdhsa--gfx950"
.text
.globl adaLN_cond__linear_kernel_hedgehog__glu_gated_reglu__prompt_kernel
.p2align 8
.type adaLN_cond__linear_kernel_hedgehog__glu_gated_reglu__prompt_kernel,@function
adaLN_cond__linear_kernel_hedgehog__glu_gated_reglu__prompt_kernel:
	s_cmp_ge_u32 s2, 256
	s_cbranch_scc1 L_end
	s_load_dwordx16 s[64:79], s[0:1], 0
	s_load_dwordx8 s[80:87], s[0:1], 64
	s_load_dwordx2 s[88:89], s[0:1], 96
	s_getpc_b64 s[90:91]
L_pc:
	s_mov_b32 s56, L_end-L_pc
	s_lshr_b32 s56, s56, 7
	s_sub_u32 s56, s56, 1
	s_lshr_b32 s55, s2, 3
	s_mul_i32 s55, s55, 12
	s_min_u32 s55, s55, s56
	s_sub_u32 s101, s56, s55
	s_lshl_b32 s101, s101, 7
	s_lshl_b32 s55, s55, 7
	s_add_u32 s90, s90, s55
	s_addc_u32 s91, s91, 0
	v_min_u32 v8, 11, v0
	v_lshlrev_b32 v8, 7, v8
	v_min_u32 v8, s101, v8
	v_mov_b32 v9, s91
	v_add_co_u32 v8, vcc, s90, v8
	s_nop 1
	v_addc_co_u32 v9, vcc, 0, v9, vcc
	global_load_dword v177, v[8:9], off
	v_and_b32 v1, 63, v0
	v_lshrrev_b32 v4, 6, v0
	v_lshlrev_b32 v2, 4, v1
	v_readfirstlane_b32 s52, v4
	s_and_b32 s48, s2, 7
	s_lshr_b32 s49, s2, 3
	s_lshr_b32 s55, s48, 1
	s_lshl_b32 s55, s55, 2
	s_lshr_b32 s56, s49, 3
	s_add_u32 s50, s55, s56
	s_and_b32 s55, s48, 1
	s_lshl_b32 s55, s55, 3
	s_and_b32 s56, s49, 7
	s_add_u32 s51, s55, s56
	s_mov_b32 s54, 0xffff0000
	s_mov_b32 s62, 0x3fb8aa3b
	s_mov_b32 s63, 0x3fb8aa3b
	s_waitcnt lgkmcnt(0)
	s_mov_b32 s0, s90
	s_mov_b32 s1, s91
	s_mov_b32 s4, s64
	s_mov_b32 s5, s65
	s_mov_b32 s6, 2097152
	s_mov_b32 s7, 0x20000
	s_mov_b32 s8, s66
	s_mov_b32 s9, s67
	s_mov_b32 s10, 1572864
	s_mov_b32 s11, 0x20000
	s_mov_b32 s12, s68
	s_mov_b32 s13, s69
	s_mov_b32 s14, 16384
	s_mov_b32 s15, 0x20000
	s_mov_b32 s16, s70
	s_mov_b32 s17, s71
	s_mov_b32 s18, 524288
	s_mov_b32 s19, 0x20000
	s_mov_b32 s20, s74
	s_mov_b32 s21, s75
	s_mov_b32 s22, 1835008
	s_mov_b32 s23, 0x20000
	s_mov_b32 s24, s76
	s_mov_b32 s25, s77
	s_mov_b32 s26, 1835008
	s_mov_b32 s27, 0x20000
	s_mov_b32 s28, s78
	s_mov_b32 s29, s79
	s_mov_b32 s30, 1835008
	s_mov_b32 s31, 0x20000
	s_mov_b32 s32, s80
	s_mov_b32 s33, s81
	s_mov_b32 s34, 1024
	s_mov_b32 s35, 0x20000
	s_mov_b32 s36, s82
	s_mov_b32 s37, s83
	s_mov_b32 s38, 3145728
	s_mov_b32 s39, 0x20000
	s_mov_b32 s40, s84
	s_mov_b32 s41, s85
	s_mov_b32 s42, 2097152
	s_mov_b32 s43, 0x20000
	s_mov_b32 s44, s88
	s_mov_b32 s45, s89
	s_mov_b32 s46, 268435456
	s_mov_b32 s47, 0x20000
	s_lshr_b32 s55, s49, 4
	s_lshl_b32 s70, s48, 1
	s_add_u32 s70, s70, s55
	s_and_b32 s71, s49, 15
	v_mov_b32 v4, 0
	buffer_load_dword v3, v4, s[44:47], 0 offen sc1
	s_lshr_b32 s55, s49, 2
	s_lshl_b32 s55, s55, 3
	s_add_u32 s55, s55, s48
	s_lshl_b32 s55, s55, 2
	s_and_b32 s56, s49, 3
	s_add_u32 s100, s55, s56
	s_lshr_b32 s55, s49, 4
	s_lshl_b32 s55, s55, 3
	s_add_u32 s55, s55, s48
	s_lshl_b32 s55, s55, 2
	s_bfe_u32 s56, s49, 131074
	s_add_u32 s3, s55, s56
	s_cmp_eq_u32 s52, 0
	s_cbranch_scc0 L_st_b_1
	buffer_load_dwordx4 v[24:27], v2, s[32:35], 0 offen
	v_lshrrev_b32 v7, 1, v1
	v_mul_u32_u24 v7, 6144, v7
	v_and_b32 v8, 1, v1
	v_lshlrev_b32 v8, 4, v8
	s_lshl_b32 s55, s3, 5
	v_add3_u32 v7, v7, v8, s55
	s_and_b32 s65, s49, 3
	s_mul_i32 s65, s65, 786432
	s_mov_b32 m0, 131072
	s_nop 0
	buffer_load_dwordx4 v7, s[36:39], s65 offen nt lds
	s_add_u32 m0, m0, 1024
	s_add_u32 s65, s65, 196608
	buffer_load_dwordx4 v7, s[36:39], s65 offen nt lds
	s_add_u32 m0, m0, 1024
	s_add_u32 s65, s65, 196608
	buffer_load_dwordx4 v7, s[36:39], s65 offen nt lds
	s_add_u32 m0, m0, 1024
	s_add_u32 s65, s65, 196608
	buffer_load_dwordx4 v7, s[36:39], s65 offen nt lds
	s_branch L_st_j_2
L_st_b_1:
	s_lshl_b32 s65, s51, 10
	s_mov_b32 m0, 153600
	s_nop 0
	buffer_load_dwordx4 v2, s[12:15], s65 offen lds
	v_lshrrev_b32 v13, 2, v1
	v_mul_u32_u24 v13, 3072, v13
	v_and_b32 v14, 3, v1
	v_lshl_add_u32 v13, v14, 7, v13
	s_mul_i32 s65, s49, 49152
	s_sub_u32 s55, s52, 1
	s_lshl_b32 s55, s55, 10
	s_add_u32 s65, s65, s55
	s_and_b32 s55, s48, 1
	s_lshl_b32 s55, s55, 9
	s_add_u32 s65, s65, s55
	buffer_load_dword v176, v13, s[8:11], s65 offen
	s_lshl_b32 s57, s50, 17
	s_and_b32 s58, s51, 7
	s_lshl_b32 s58, s58, 4
	s_add_u32 s58, s58, s52
	s_sub_u32 s58, s58, 1
	s_mov_b32 s59, 4
L_xrow_3:
	s_and_b32 s55, s58, 127
	s_and_b32 s56, s55, 15
	s_lshl_b32 s56, s56, 4
	v_xor_b32 v9, s56, v2
	s_lshl_b32 m0, s55, 10
	s_add_u32 s65, m0, s57
	buffer_load_dwordx4 v9, s[4:7], s65 offen lds
	s_add_u32 s58, s58, 3
	s_and_b32 s55, s58, 127
	s_and_b32 s56, s55, 15
	s_lshl_b32 s56, s56, 4
	v_xor_b32 v9, s56, v2
	s_lshl_b32 m0, s55, 10
	s_add_u32 s65, m0, s57
	buffer_load_dwordx4 v9, s[4:7], s65 offen lds
	s_add_u32 s58, s58, 3
	s_and_b32 s55, s58, 127
	s_and_b32 s56, s55, 15
	s_lshl_b32 s56, s56, 4
	v_xor_b32 v9, s56, v2
	s_lshl_b32 m0, s55, 10
	s_add_u32 s65, m0, s57
	buffer_load_dwordx4 v9, s[4:7], s65 offen lds
	s_add_u32 s58, s58, 3
	s_and_b32 s55, s58, 127
	s_and_b32 s56, s55, 15
	s_lshl_b32 s56, s56, 4
	v_xor_b32 v9, s56, v2
	s_lshl_b32 m0, s55, 10
	s_add_u32 s65, m0, s57
	buffer_load_dwordx4 v9, s[4:7], s65 offen lds
	s_add_u32 s58, s58, 3
	s_and_b32 s55, s58, 127
	s_and_b32 s56, s55, 15
	s_lshl_b32 s56, s56, 4
	v_xor_b32 v9, s56, v2
	s_lshl_b32 m0, s55, 10
	s_add_u32 s65, m0, s57
	buffer_load_dwordx4 v9, s[4:7], s65 offen lds
	s_add_u32 s58, s58, 3
	s_and_b32 s55, s58, 127
	s_and_b32 s56, s55, 15
	s_lshl_b32 s56, s56, 4
	v_xor_b32 v9, s56, v2
	s_lshl_b32 m0, s55, 10
	s_add_u32 s65, m0, s57
	buffer_load_dwordx4 v9, s[4:7], s65 offen lds
	s_add_u32 s58, s58, 3
	s_and_b32 s55, s58, 127
	s_and_b32 s56, s55, 15
	s_lshl_b32 s56, s56, 4
	v_xor_b32 v9, s56, v2
	s_lshl_b32 m0, s55, 10
	s_add_u32 s65, m0, s57
	buffer_load_dwordx4 v9, s[4:7], s65 offen lds
	s_add_u32 s58, s58, 3
	s_and_b32 s55, s58, 127
	s_and_b32 s56, s55, 15
	s_lshl_b32 s56, s56, 4
	v_xor_b32 v9, s56, v2
	s_lshl_b32 m0, s55, 10
	s_add_u32 s65, m0, s57
	buffer_load_dwordx4 v9, s[4:7], s65 offen lds
	s_add_u32 s58, s58, 3
	s_and_b32 s55, s58, 127
	s_and_b32 s56, s55, 15
	s_lshl_b32 s56, s56, 4
	v_xor_b32 v9, s56, v2
	s_lshl_b32 m0, s55, 10
	s_add_u32 s65, m0, s57
	buffer_load_dwordx4 v9, s[4:7], s65 offen lds
	s_add_u32 s58, s58, 3
	s_and_b32 s55, s58, 127
	s_and_b32 s56, s55, 15
	s_lshl_b32 s56, s56, 4
	v_xor_b32 v9, s56, v2
	s_lshl_b32 m0, s55, 10
	s_add_u32 s65, m0, s57
	buffer_load_dwordx4 v9, s[4:7], s65 offen lds
	s_add_u32 s58, s58, 3
	s_and_b32 s55, s58, 127
	s_and_b32 s56, s55, 15
	s_lshl_b32 s56, s56, 4
	v_xor_b32 v9, s56, v2
	s_lshl_b32 m0, s55, 10
	s_add_u32 s65, m0, s57
	buffer_load_dwordx4 v9, s[4:7], s65 offen lds
	s_add_u32 s58, s58, 3
	s_sub_u32 s59, s59, 1
	s_cmp_lg_u32 s59, 0
	s_cbranch_scc1 L_xrow_3
L_st_j_2:
	v_mov_b32 v8, 0
	v_lshlrev_b32 v9, 2, v1
	v_and_b32 v9, 60, v9
	v_add_u32 v9, 154624, v9
	ds_write_b32 v9, v8
	v_bfe_u32 v8, v1, 1, 2
	v_bfe_u32 v9, v1, 4, 1
	v_lshl_add_u32 v8, v9, 2, v8
	v_bfe_u32 v9, v1, 3, 1
	v_lshrrev_b32 v10, 5, v1
	v_xor_b32 v9, v9, v10
	v_lshl_add_u32 v8, v9, 3, v8
	v_cmp_eq_u32 vcc, 0, v8
	s_nop 1
	v_cndmask_b32 v212, 0, -1, vcc
	v_cmp_eq_u32 vcc, 1, v8
	s_nop 1
	v_cndmask_b32 v213, 0, -1, vcc
	v_cmp_eq_u32 vcc, 2, v8
	s_nop 1
	v_cndmask_b32 v214, 0, -1, vcc
	v_cmp_eq_u32 vcc, 3, v8
	s_nop 1
	v_cndmask_b32 v215, 0, -1, vcc
	v_cmp_eq_u32 vcc, 4, v8
	s_nop 1
	v_cndmask_b32 v216, 0, -1, vcc
	v_cmp_eq_u32 vcc, 5, v8
	s_nop 1
	v_cndmask_b32 v217, 0, -1, vcc
	v_cmp_eq_u32 vcc, 6, v8
	s_nop 1
	v_cndmask_b32 v218, 0, -1, vcc
	v_cmp_eq_u32 vcc, 7, v8
	s_nop 1
	v_cndmask_b32 v219, 0, -1, vcc
	v_lshrrev_b32 v8, 5, v1
	v_bfe_u32 v11, v1, 4, 1
	v_bfe_u32 v9, v1, 2, 2
	v_and_b32 v10, 3, v1
	v_and_b32 v13, 1, v10
	v_lshlrev_b32 v13, 5, v13
	v_lshrrev_b32 v14, 1, v10
	v_lshlrev_b32 v14, 3, v14
	v_lshl_add_u32 v12, v11, 4, v13
	v_add_u32 v12, v12, v14
	v_lshl_add_u32 v8, v8, 2, v9
	v_lshlrev_b32 v13, 7, v8
	v_lshrrev_b32 v9, 1, v9
	v_lshl_add_u32 v13, v9, 6, v13
	v_add_u32 v220, v13, v12
	v_xor_b32 v221, 64, v220
	v_lshlrev_b32 v13, 6, v8
	v_add_u32 v13, v13, v12
	v_add_u32 v4, 65536, v13
	v_and_b32 v8, 31, v1
	v_lshlrev_b32 v8, 4, v8
	v_add_u32 v222, 139264, v8
	v_bfe_u32 v8, v1, 3, 1
	v_and_b32 v9, 3, v1
	v_lshl_add_u32 v8, v8, 2, v9
	v_and_b32 v9, 1, v8
	v_lshlrev_b32 v9, 4, v9
	v_mov_b32 v10, 0x3f80
	v_lshlrev_b32 v9, v9, v10
	v_lshrrev_b32 v8, 1, v8
	v_bfe_u32 v10, v1, 4, 1
	v_bfe_u32 v11, v1, 2, 1
	v_lshrrev_b32 v12, 5, v1
	v_xor_b32 v11, v11, v12
	v_cmp_eq_u32 s[66:67], 0, v11
	v_lshl_add_u32 v13, v10, 2, v8
	v_lshl_add_u32 v13, v11, 3, v13
	v_cmp_eq_u32 vcc, 0, v13
	s_nop 1
	v_cndmask_b32 v14, 0, v9, vcc
	v_accvgpr_write_b32 a232, v14
	v_cmp_eq_u32 vcc, 1, v13
	s_nop 1
	v_cndmask_b32 v14, 0, v9, vcc
	v_accvgpr_write_b32 a233, v14
	v_cmp_eq_u32 vcc, 2, v13
	s_nop 1
	v_cndmask_b32 v14, 0, v9, vcc
	v_accvgpr_write_b32 a234, v14
	v_cmp_eq_u32 vcc, 3, v13
	s_nop 1
	v_cndmask_b32 v14, 0, v9, vcc
	v_accvgpr_write_b32 a235, v14
	v_cmp_eq_u32 vcc, 4, v13
	s_nop 1
	v_cndmask_b32 v14, 0, v9, vcc
	v_accvgpr_write_b32 a236, v14
	v_cmp_eq_u32 vcc, 5, v13
	s_nop 1
	v_cndmask_b32 v14, 0, v9, vcc
	v_accvgpr_write_b32 a237, v14
	v_cmp_eq_u32 vcc, 6, v13
	s_nop 1
	v_cndmask_b32 v14, 0, v9, vcc
	v_accvgpr_write_b32 a238, v14
	v_cmp_eq_u32 vcc, 7, v13
	s_nop 1
	v_cndmask_b32 v14, 0, v9, vcc
	v_accvgpr_write_b32 a239, v14
	v_cmp_eq_u32 vcc, 8, v13
	s_nop 1
	v_cndmask_b32 v14, 0, v9, vcc
	v_accvgpr_write_b32 a240, v14
	v_cmp_eq_u32 vcc, 9, v13
	s_nop 1
	v_cndmask_b32 v14, 0, v9, vcc
	v_accvgpr_write_b32 a241, v14
	v_cmp_eq_u32 vcc, 10, v13
	s_nop 1
	v_cndmask_b32 v14, 0, v9, vcc
	v_accvgpr_write_b32 a242, v14
	v_cmp_eq_u32 vcc, 11, v13
	s_nop 1
	v_cndmask_b32 v14, 0, v9, vcc
	v_accvgpr_write_b32 a243, v14
	v_cmp_eq_u32 vcc, 12, v13
	s_nop 1
	v_cndmask_b32 v14, 0, v9, vcc
	v_accvgpr_write_b32 a244, v14
	v_cmp_eq_u32 vcc, 13, v13
	s_nop 1
	v_cndmask_b32 v14, 0, v9, vcc
	v_accvgpr_write_b32 a245, v14
	v_cmp_eq_u32 vcc, 14, v13
	s_nop 1
	v_cndmask_b32 v14, 0, v9, vcc
	v_accvgpr_write_b32 a246, v14
	v_cmp_eq_u32 vcc, 15, v13
	s_nop 1
	v_cndmask_b32 v14, 0, v9, vcc
	v_accvgpr_write_b32 a247, v14
	v_and_b32 v8, 31, v1
	s_lshl_b32 s55, s52, 5
	v_add_u32 v9, s55, v8
	v_lshlrev_b32 v9, 10, v9
	v_and_b32 v8, 15, v8
	v_lshrrev_b32 v10, 5, v1
	v_add_u32 v11, 0, v10
	v_xor_b32 v11, v11, v8
	v_lshl_add_u32 v192, v11, 4, v9
	v_add_u32 v11, 2, v10
	v_xor_b32 v11, v11, v8
	v_lshl_add_u32 v193, v11, 4, v9
	v_add_u32 v11, 4, v10
	v_xor_b32 v11, v11, v8
	v_lshl_add_u32 v194, v11, 4, v9
	v_add_u32 v11, 6, v10
	v_xor_b32 v11, v11, v8
	v_lshl_add_u32 v195, v11, 4, v9
	v_add_u32 v11, 8, v10
	v_xor_b32 v11, v11, v8
	v_lshl_add_u32 v196, v11, 4, v9
	v_add_u32 v11, 10, v10
	v_xor_b32 v11, v11, v8
	v_lshl_add_u32 v197, v11, 4, v9
	v_add_u32 v11, 12, v10
	v_xor_b32 v11, v11, v8
	v_lshl_add_u32 v198, v11, 4, v9
	v_add_u32 v11, 14, v10
	v_xor_b32 v11, v11, v8
	v_lshl_add_u32 v199, v11, 4, v9
	v_lshrrev_b32 v8, 3, v1
	v_mul_u32_u24 v8, 3072, v8
	v_and_b32 v9, 7, v1
	v_bfe_u32 v10, v1, 4, 1
	v_lshlrev_b32 v10, 2, v10
	v_xor_b32 v9, v9, v10
	v_lshrrev_b32 v10, 2, v9
	v_lshlrev_b32 v10, 10, v10
	v_and_b32 v9, 3, v9
	v_lshl_add_u32 v10, v9, 4, v10
	s_lshl_b32 s55, s51, 6
	s_add_u32 s56, s55, 1024
	v_add3_u32 v200, v8, v10, s56
	v_lshrrev_b32 v8, 2, v1
	v_mul_u32_u24 v8, 3072, v8
	v_and_b32 v9, 3, v1
	v_lshl_add_u32 v8, v9, 4, v8
	v_add_u32 v6, s55, v8
	v_lshlrev_b32 v202, 4, v0
	v_add_u32 v202, 393216, v202
	v_add_u32 v203, 8192, v202
	v_add_u32 v204, 16384, v202
	v_add_u32 v205, 24576, v202
	v_add_u32 v206, 4096, v202
	v_add_u32 v207, 4096, v203
	v_add_u32 v241, 4096, v204
	v_add_u32 v242, 4096, v205
	s_cmp_eq_u32 s52, 0
	s_cbranch_scc0 L_sf_b_4
	s_waitcnt vmcnt(4)
	v_add_u32 v3, 1, v3
	v_lshlrev_b32 v28, 16, v24
	v_and_b32 v29, s54, v24
	v_lshlrev_b32 v30, 16, v25
	v_and_b32 v31, s54, v25
	v_lshlrev_b32 v32, 16, v26
	v_and_b32 v33, s54, v26
	v_lshlrev_b32 v34, 16, v27
	v_and_b32 v35, s54, v27
	v_mul_f32 v36, s62, v28
	v_mul_f32 v37, s62, v29
	v_mul_f32 v38, s62, v30
	v_mul_f32 v39, s62, v31
	v_mul_f32 v40, s62, v32
	v_mul_f32 v41, s62, v33
	v_mul_f32 v42, s62, v34
	v_mul_f32 v43, s62, v35
	v_exp_f32 v36, -v36
	v_exp_f32 v37, -v37
	v_exp_f32 v38, -v38
	v_exp_f32 v39, -v39
	v_exp_f32 v40, -v40
	v_exp_f32 v41, -v41
	v_exp_f32 v42, -v42
	v_exp_f32 v43, -v43
	v_add_f32 v36, 1.0, v36
	v_add_f32 v37, 1.0, v37
	v_add_f32 v38, 1.0, v38
	v_add_f32 v39, 1.0, v39
	v_add_f32 v40, 1.0, v40
	v_add_f32 v41, 1.0, v41
	v_add_f32 v42, 1.0, v42
	v_add_f32 v43, 1.0, v43
	v_rcp_f32 v36, v36
	v_rcp_f32 v37, v37
	v_rcp_f32 v38, v38
	v_rcp_f32 v39, v39
	v_rcp_f32 v40, v40
	v_rcp_f32 v41, v41
	v_rcp_f32 v42, v42
	v_rcp_f32 v43, v43
	v_mul_f32 v28, v28, v36
	v_mul_f32 v29, v29, v37
	v_mul_f32 v30, v30, v38
	v_mul_f32 v31, v31, v39
	v_mul_f32 v32, v32, v40
	v_mul_f32 v33, v33, v41
	v_mul_f32 v34, v34, v42
	v_mul_f32 v35, v35, v43
	v_cvt_pk_bf16_f32 v24, v28, v29
	v_cvt_pk_bf16_f32 v25, v30, v31
	v_cvt_pk_bf16_f32 v26, v32, v33
	v_cvt_pk_bf16_f32 v27, v34, v35
	v_add_u32 v8, 158720, v2
	ds_write_b128 v8, v[24:27]
	s_waitcnt vmcnt(0) lgkmcnt(0)
	v_lshrrev_b32 v8, 4, v1
	v_lshlrev_b32 v8, 3, v8
	v_add_u32 v8, 158720, v8
	s_and_b32 s55, s49, 3
	s_lshl_b32 s55, s55, 8
	v_add_u32 v8, s55, v8
	v_lshlrev_b32 v10, 3, v1
	v_add_u32 v10, 131072, v10
	ds_read_b64_tr_b16 v[116:117], v10 offset:0
	ds_read_b64_tr_b16 v[118:119], v10 offset:512
	ds_read_b64 v[112:113], v8 offset:0
	ds_read_b64 v[114:115], v8 offset:32
	ds_read_b64_tr_b16 v[124:125], v10 offset:1024
	ds_read_b64_tr_b16 v[126:127], v10 offset:1536
	ds_read_b64 v[120:121], v8 offset:64
	ds_read_b64 v[122:123], v8 offset:96
	ds_read_b64_tr_b16 v[132:133], v10 offset:2048
	ds_read_b64_tr_b16 v[134:135], v10 offset:2560
	ds_read_b64 v[128:129], v8 offset:128
	ds_read_b64 v[130:131], v8 offset:160
	s_waitcnt lgkmcnt(8)
	v_mfma_f32_16x16x32_bf16 v[144:147], v[112:115], v[116:119], 0
	ds_read_b64_tr_b16 v[140:141], v10 offset:3072
	ds_read_b64_tr_b16 v[142:143], v10 offset:3584
	ds_read_b64 v[136:137], v8 offset:192
	ds_read_b64 v[138:139], v8 offset:224
	s_waitcnt lgkmcnt(8)
	v_mfma_f32_16x16x32_bf16 v[148:151], v[120:123], v[124:127], 0
	s_waitcnt lgkmcnt(4)
	v_mfma_f32_16x16x32_bf16 v[144:147], v[128:131], v[132:135], v[144:147]
	s_waitcnt lgkmcnt(0)
	v_mfma_f32_16x16x32_bf16 v[148:151], v[136:139], v[140:143], v[148:151]
	s_nop 7
	v_add_f32 v144, v144, v148
	s_nop 1
	v_mov_b32_dpp v145, v144 quad_perm:[1,0,3,2] row_mask:0xf bank_mask:0xf
	v_mov_b32 v146, v3
	v_mov_b32 v147, 0
	v_lshlrev_b32 v8, 3, v1
	s_and_b32 s55, s49, 3
	s_lshl_b32 s55, s55, 13
	s_lshl_b32 s56, s3, 7
	s_add_u32 s55, s55, s56
	s_add_u32 s55, s55, 393216
	v_add_u32 v8, s55, v8
	s_mov_b64 exec, 0x5555
	buffer_store_dwordx4 v[144:147], v8, s[44:47], 0 offen sc1
	s_mov_b64 exec, -1
	s_branch L_sf_j_5
L_sf_b_4:
	s_waitcnt vmcnt(0)
	v_add_u32 v3, 1, v3
L_sf_j_5:
	s_nop 0
	v_readfirstlane_b32 s53, v3
	s_barrier
	v_mov_b32 v8, 0x3f803f80
	v_mov_b32 v10, 0
	v_mov_b32 v11, 0
	v_mov_b32 v12, 0
	v_mov_b32 v13, 0
	ds_read_b128 v[16:19], v192 offset:0
	ds_read_b128 v[20:23], v193 offset:0
	ds_read_b128 v[24:27], v194 offset:0
	ds_read_b128 v[28:31], v195 offset:0
	ds_read_b128 v[32:35], v196 offset:0
	ds_read_b128 v[36:39], v197 offset:0
	ds_read_b128 v[40:43], v198 offset:0
	s_waitcnt lgkmcnt(6)
	v_dot2c_f32_bf16 v10, v16, v8
	v_dot2c_f32_bf16 v12, v16, v16
	v_dot2c_f32_bf16 v11, v17, v8
	v_dot2c_f32_bf16 v13, v17, v17
	v_dot2c_f32_bf16 v10, v18, v8
	v_dot2c_f32_bf16 v12, v18, v18
	v_dot2c_f32_bf16 v11, v19, v8
	v_dot2c_f32_bf16 v13, v19, v19
	ds_read_b128 v[44:47], v199 offset:0
	s_waitcnt lgkmcnt(6)
	v_dot2c_f32_bf16 v10, v20, v8
	v_dot2c_f32_bf16 v12, v20, v20
	v_dot2c_f32_bf16 v11, v21, v8
	v_dot2c_f32_bf16 v13, v21, v21
	v_dot2c_f32_bf16 v10, v22, v8
	v_dot2c_f32_bf16 v12, v22, v22
	v_dot2c_f32_bf16 v11, v23, v8
	v_dot2c_f32_bf16 v13, v23, v23
	ds_read_b128 v[48:51], v192 offset:256
	s_waitcnt lgkmcnt(6)
	v_dot2c_f32_bf16 v10, v24, v8
	v_dot2c_f32_bf16 v12, v24, v24
	v_dot2c_f32_bf16 v11, v25, v8
	v_dot2c_f32_bf16 v13, v25, v25
	v_dot2c_f32_bf16 v10, v26, v8
	v_dot2c_f32_bf16 v12, v26, v26
	v_dot2c_f32_bf16 v11, v27, v8
	v_dot2c_f32_bf16 v13, v27, v27
	ds_read_b128 v[52:55], v193 offset:256
	s_waitcnt lgkmcnt(6)
	v_dot2c_f32_bf16 v10, v28, v8
	v_dot2c_f32_bf16 v12, v28, v28
	v_dot2c_f32_bf16 v11, v29, v8
	v_dot2c_f32_bf16 v13, v29, v29
	v_dot2c_f32_bf16 v10, v30, v8
	v_dot2c_f32_bf16 v12, v30, v30
	v_dot2c_f32_bf16 v11, v31, v8
	v_dot2c_f32_bf16 v13, v31, v31
	ds_read_b128 v[56:59], v194 offset:256
	s_waitcnt lgkmcnt(6)
	v_dot2c_f32_bf16 v10, v32, v8
	v_dot2c_f32_bf16 v12, v32, v32
	v_dot2c_f32_bf16 v11, v33, v8
	v_dot2c_f32_bf16 v13, v33, v33
	v_dot2c_f32_bf16 v10, v34, v8
	v_dot2c_f32_bf16 v12, v34, v34
	v_dot2c_f32_bf16 v11, v35, v8
	v_dot2c_f32_bf16 v13, v35, v35
	ds_read_b128 v[60:63], v195 offset:256
	s_waitcnt lgkmcnt(6)
	v_dot2c_f32_bf16 v10, v36, v8
	v_dot2c_f32_bf16 v12, v36, v36
	v_dot2c_f32_bf16 v11, v37, v8
	v_dot2c_f32_bf16 v13, v37, v37
	v_dot2c_f32_bf16 v10, v38, v8
	v_dot2c_f32_bf16 v12, v38, v38
	v_dot2c_f32_bf16 v11, v39, v8
	v_dot2c_f32_bf16 v13, v39, v39
	ds_read_b128 v[64:67], v196 offset:256
	s_waitcnt lgkmcnt(6)
	v_dot2c_f32_bf16 v10, v40, v8
	v_dot2c_f32_bf16 v12, v40, v40
	v_dot2c_f32_bf16 v11, v41, v8
	v_dot2c_f32_bf16 v13, v41, v41
	v_dot2c_f32_bf16 v10, v42, v8
	v_dot2c_f32_bf16 v12, v42, v42
	v_dot2c_f32_bf16 v11, v43, v8
	v_dot2c_f32_bf16 v13, v43, v43
	ds_read_b128 v[68:71], v197 offset:256
	s_waitcnt lgkmcnt(6)
	v_dot2c_f32_bf16 v10, v44, v8
	v_dot2c_f32_bf16 v12, v44, v44
	v_dot2c_f32_bf16 v11, v45, v8
	v_dot2c_f32_bf16 v13, v45, v45
	v_dot2c_f32_bf16 v10, v46, v8
	v_dot2c_f32_bf16 v12, v46, v46
	v_dot2c_f32_bf16 v11, v47, v8
	v_dot2c_f32_bf16 v13, v47, v47
	ds_read_b128 v[72:75], v198 offset:256
	s_waitcnt lgkmcnt(6)
	v_dot2c_f32_bf16 v10, v48, v8
	v_dot2c_f32_bf16 v12, v48, v48
	v_dot2c_f32_bf16 v11, v49, v8
	v_dot2c_f32_bf16 v13, v49, v49
	v_dot2c_f32_bf16 v10, v50, v8
	v_dot2c_f32_bf16 v12, v50, v50
	v_dot2c_f32_bf16 v11, v51, v8
	v_dot2c_f32_bf16 v13, v51, v51
	ds_read_b128 v[76:79], v199 offset:256
	s_waitcnt lgkmcnt(6)
	v_dot2c_f32_bf16 v10, v52, v8
	v_dot2c_f32_bf16 v12, v52, v52
	v_dot2c_f32_bf16 v11, v53, v8
	v_dot2c_f32_bf16 v13, v53, v53
	v_dot2c_f32_bf16 v10, v54, v8
	v_dot2c_f32_bf16 v12, v54, v54
	v_dot2c_f32_bf16 v11, v55, v8
	v_dot2c_f32_bf16 v13, v55, v55
	ds_read_b128 v[80:83], v192 offset:512
	s_waitcnt lgkmcnt(6)
	v_dot2c_f32_bf16 v10, v56, v8
	v_dot2c_f32_bf16 v12, v56, v56
	v_dot2c_f32_bf16 v11, v57, v8
	v_dot2c_f32_bf16 v13, v57, v57
	v_dot2c_f32_bf16 v10, v58, v8
	v_dot2c_f32_bf16 v12, v58, v58
	v_dot2c_f32_bf16 v11, v59, v8
	v_dot2c_f32_bf16 v13, v59, v59
	ds_read_b128 v[84:87], v193 offset:512
	s_waitcnt lgkmcnt(6)
	v_dot2c_f32_bf16 v10, v60, v8
	v_dot2c_f32_bf16 v12, v60, v60
	v_dot2c_f32_bf16 v11, v61, v8
	v_dot2c_f32_bf16 v13, v61, v61
	v_dot2c_f32_bf16 v10, v62, v8
	v_dot2c_f32_bf16 v12, v62, v62
	v_dot2c_f32_bf16 v11, v63, v8
	v_dot2c_f32_bf16 v13, v63, v63
	ds_read_b128 v[88:91], v194 offset:512
	s_waitcnt lgkmcnt(6)
	v_dot2c_f32_bf16 v10, v64, v8
	v_dot2c_f32_bf16 v12, v64, v64
	v_dot2c_f32_bf16 v11, v65, v8
	v_dot2c_f32_bf16 v13, v65, v65
	v_dot2c_f32_bf16 v10, v66, v8
	v_dot2c_f32_bf16 v12, v66, v66
	v_dot2c_f32_bf16 v11, v67, v8
	v_dot2c_f32_bf16 v13, v67, v67
	ds_read_b128 v[92:95], v195 offset:512
	s_waitcnt lgkmcnt(6)
	v_dot2c_f32_bf16 v10, v68, v8
	v_dot2c_f32_bf16 v12, v68, v68
	v_dot2c_f32_bf16 v11, v69, v8
	v_dot2c_f32_bf16 v13, v69, v69
	v_dot2c_f32_bf16 v10, v70, v8
	v_dot2c_f32_bf16 v12, v70, v70
	v_dot2c_f32_bf16 v11, v71, v8
	v_dot2c_f32_bf16 v13, v71, v71
	ds_read_b128 v[96:99], v196 offset:512
	s_waitcnt lgkmcnt(6)
	v_dot2c_f32_bf16 v10, v72, v8
	v_dot2c_f32_bf16 v12, v72, v72
	v_dot2c_f32_bf16 v11, v73, v8
	v_dot2c_f32_bf16 v13, v73, v73
	v_dot2c_f32_bf16 v10, v74, v8
	v_dot2c_f32_bf16 v12, v74, v74
	v_dot2c_f32_bf16 v11, v75, v8
	v_dot2c_f32_bf16 v13, v75, v75
	ds_read_b128 v[100:103], v197 offset:512
	s_waitcnt lgkmcnt(6)
	v_dot2c_f32_bf16 v10, v76, v8
	v_dot2c_f32_bf16 v12, v76, v76
	v_dot2c_f32_bf16 v11, v77, v8
	v_dot2c_f32_bf16 v13, v77, v77
	v_dot2c_f32_bf16 v10, v78, v8
	v_dot2c_f32_bf16 v12, v78, v78
	v_dot2c_f32_bf16 v11, v79, v8
	v_dot2c_f32_bf16 v13, v79, v79
	ds_read_b128 v[104:107], v198 offset:512
	s_waitcnt lgkmcnt(6)
	v_dot2c_f32_bf16 v10, v80, v8
	v_dot2c_f32_bf16 v12, v80, v80
	v_dot2c_f32_bf16 v11, v81, v8
	v_dot2c_f32_bf16 v13, v81, v81
	v_dot2c_f32_bf16 v10, v82, v8
	v_dot2c_f32_bf16 v12, v82, v82
	v_dot2c_f32_bf16 v11, v83, v8
	v_dot2c_f32_bf16 v13, v83, v83
	ds_read_b128 v[108:111], v199 offset:512
	s_waitcnt lgkmcnt(6)
	v_dot2c_f32_bf16 v10, v84, v8
	v_dot2c_f32_bf16 v12, v84, v84
	v_dot2c_f32_bf16 v11, v85, v8
	v_dot2c_f32_bf16 v13, v85, v85
	v_dot2c_f32_bf16 v10, v86, v8
	v_dot2c_f32_bf16 v12, v86, v86
	v_dot2c_f32_bf16 v11, v87, v8
	v_dot2c_f32_bf16 v13, v87, v87
	ds_read_b128 v[112:115], v192 offset:768
	s_waitcnt lgkmcnt(6)
	v_dot2c_f32_bf16 v10, v88, v8
	v_dot2c_f32_bf16 v12, v88, v88
	v_dot2c_f32_bf16 v11, v89, v8
	v_dot2c_f32_bf16 v13, v89, v89
	v_dot2c_f32_bf16 v10, v90, v8
	v_dot2c_f32_bf16 v12, v90, v90
	v_dot2c_f32_bf16 v11, v91, v8
	v_dot2c_f32_bf16 v13, v91, v91
	ds_read_b128 v[116:119], v193 offset:768
	s_waitcnt lgkmcnt(6)
	v_dot2c_f32_bf16 v10, v92, v8
	v_dot2c_f32_bf16 v12, v92, v92
	v_dot2c_f32_bf16 v11, v93, v8
	v_dot2c_f32_bf16 v13, v93, v93
	v_dot2c_f32_bf16 v10, v94, v8
	v_dot2c_f32_bf16 v12, v94, v94
	v_dot2c_f32_bf16 v11, v95, v8
	v_dot2c_f32_bf16 v13, v95, v95
	ds_read_b128 v[120:123], v194 offset:768
	ds_read_b128 v[124:127], v195 offset:768
	ds_read_b128 v[128:131], v196 offset:768
	ds_read_b128 v[132:135], v197 offset:768
	ds_read_b128 v[136:139], v198 offset:768
	ds_read_b128 v[140:143], v199 offset:768
	s_waitcnt lgkmcnt(0)
	s_barrier
	s_mul_i32 s57, s52, 393216
	s_lshl_b32 s58, s52, 14
	buffer_load_dwordx4 v[144:147], v202, s[44:47], 0 offen offset:0 sc1
	v_dot2c_f32_bf16 v10, v96, v8
	v_dot2c_f32_bf16 v12, v96, v96
	v_dot2c_f32_bf16 v11, v97, v8
	buffer_load_dwordx4 v[148:151], v203, s[44:47], 0 offen offset:0 sc1
	v_dot2c_f32_bf16 v13, v97, v97
	v_dot2c_f32_bf16 v10, v98, v8
	v_dot2c_f32_bf16 v12, v98, v98
	buffer_load_dwordx4 v[152:155], v204, s[44:47], 0 offen offset:0 sc1
	v_dot2c_f32_bf16 v11, v99, v8
	v_dot2c_f32_bf16 v13, v99, v99
	v_dot2c_f32_bf16 v10, v100, v8
	buffer_load_dwordx4 v[156:159], v205, s[44:47], 0 offen offset:0 sc1
	v_dot2c_f32_bf16 v12, v100, v100
	v_dot2c_f32_bf16 v11, v101, v8
	v_dot2c_f32_bf16 v13, v101, v101
	buffer_load_dwordx4 v[160:163], v206, s[44:47], 0 offen offset:0 sc1
	v_dot2c_f32_bf16 v10, v102, v8
	v_dot2c_f32_bf16 v12, v102, v102
	v_dot2c_f32_bf16 v11, v103, v8
	buffer_load_dwordx4 v[164:167], v207, s[44:47], 0 offen offset:0 sc1
	v_dot2c_f32_bf16 v13, v103, v103
	v_dot2c_f32_bf16 v10, v104, v8
	v_dot2c_f32_bf16 v12, v104, v104
	buffer_load_dwordx4 v[168:171], v241, s[44:47], 0 offen offset:0 sc1
	v_dot2c_f32_bf16 v11, v105, v8
	v_dot2c_f32_bf16 v13, v105, v105
	v_dot2c_f32_bf16 v10, v106, v8
	buffer_load_dwordx4 v[172:175], v242, s[44:47], 0 offen offset:0 sc1
	v_dot2c_f32_bf16 v12, v106, v106
	v_dot2c_f32_bf16 v11, v107, v8
	v_dot2c_f32_bf16 v13, v107, v107
	s_add_u32 s65, s57, 0
	s_add_u32 m0, s58, 0
	s_nop 0
	buffer_load_dwordx4 v200, s[8:11], s65 offen lds
	v_dot2c_f32_bf16 v10, v108, v8
	v_dot2c_f32_bf16 v12, v108, v108
	v_dot2c_f32_bf16 v11, v109, v8
	v_dot2c_f32_bf16 v13, v109, v109
	s_add_u32 s65, s57, 24576
	s_add_u32 m0, s58, 1024
	s_nop 0
	buffer_load_dwordx4 v200, s[8:11], s65 offen lds
	v_dot2c_f32_bf16 v10, v110, v8
	v_dot2c_f32_bf16 v12, v110, v110
	v_dot2c_f32_bf16 v11, v111, v8
	v_dot2c_f32_bf16 v13, v111, v111
	s_add_u32 s65, s57, 49152
	s_add_u32 m0, s58, 2048
	s_nop 0
	buffer_load_dwordx4 v200, s[8:11], s65 offen lds
	v_dot2c_f32_bf16 v10, v112, v8
	v_dot2c_f32_bf16 v12, v112, v112
	v_dot2c_f32_bf16 v11, v113, v8
	v_dot2c_f32_bf16 v13, v113, v113
	s_add_u32 s65, s57, 73728
	s_add_u32 m0, s58, 3072
	s_nop 0
	buffer_load_dwordx4 v200, s[8:11], s65 offen lds
	v_dot2c_f32_bf16 v10, v114, v8
	v_dot2c_f32_bf16 v12, v114, v114
	v_dot2c_f32_bf16 v11, v115, v8
	v_dot2c_f32_bf16 v13, v115, v115
	s_add_u32 s65, s57, 98304
	s_add_u32 m0, s58, 4096
	s_nop 0
	buffer_load_dwordx4 v200, s[8:11], s65 offen lds
	v_dot2c_f32_bf16 v10, v116, v8
	v_dot2c_f32_bf16 v12, v116, v116
	v_dot2c_f32_bf16 v11, v117, v8
	v_dot2c_f32_bf16 v13, v117, v117
	s_add_u32 s65, s57, 122880
	s_add_u32 m0, s58, 5120
	s_nop 0
	buffer_load_dwordx4 v200, s[8:11], s65 offen lds
	v_dot2c_f32_bf16 v10, v118, v8
	v_dot2c_f32_bf16 v12, v118, v118
	v_dot2c_f32_bf16 v11, v119, v8
	v_dot2c_f32_bf16 v13, v119, v119
	s_add_u32 s65, s57, 147456
	s_add_u32 m0, s58, 6144
	s_nop 0
	buffer_load_dwordx4 v200, s[8:11], s65 offen lds
	v_dot2c_f32_bf16 v10, v120, v8
	v_dot2c_f32_bf16 v12, v120, v120
	v_dot2c_f32_bf16 v11, v121, v8
	v_dot2c_f32_bf16 v13, v121, v121
	s_add_u32 s65, s57, 172032
	s_add_u32 m0, s58, 7168
	s_nop 0
	buffer_load_dwordx4 v200, s[8:11], s65 offen lds
	v_dot2c_f32_bf16 v10, v122, v8
	v_dot2c_f32_bf16 v12, v122, v122
	v_dot2c_f32_bf16 v11, v123, v8
	v_dot2c_f32_bf16 v13, v123, v123
	s_add_u32 s65, s57, 196608
	s_add_u32 m0, s58, 8192
	s_nop 0
	buffer_load_dwordx4 v200, s[8:11], s65 offen lds
	v_dot2c_f32_bf16 v10, v124, v8
	v_dot2c_f32_bf16 v12, v124, v124
	v_dot2c_f32_bf16 v11, v125, v8
	v_dot2c_f32_bf16 v13, v125, v125
	s_add_u32 s65, s57, 221184
	s_add_u32 m0, s58, 9216
	s_nop 0
	buffer_load_dwordx4 v200, s[8:11], s65 offen lds
	v_dot2c_f32_bf16 v10, v126, v8
	v_dot2c_f32_bf16 v12, v126, v126
	v_dot2c_f32_bf16 v11, v127, v8
	v_dot2c_f32_bf16 v13, v127, v127
	s_add_u32 s65, s57, 245760
	s_add_u32 m0, s58, 10240
	s_nop 0
	buffer_load_dwordx4 v200, s[8:11], s65 offen lds
	v_dot2c_f32_bf16 v10, v128, v8
	v_dot2c_f32_bf16 v12, v128, v128
	v_dot2c_f32_bf16 v11, v129, v8
	v_dot2c_f32_bf16 v13, v129, v129
	s_add_u32 s65, s57, 270336
	s_add_u32 m0, s58, 11264
	s_nop 0
	buffer_load_dwordx4 v200, s[8:11], s65 offen lds
	v_dot2c_f32_bf16 v10, v130, v8
	v_dot2c_f32_bf16 v12, v130, v130
	v_dot2c_f32_bf16 v11, v131, v8
	v_dot2c_f32_bf16 v13, v131, v131
	s_add_u32 s65, s57, 294912
	s_add_u32 m0, s58, 12288
	s_nop 0
	buffer_load_dwordx4 v200, s[8:11], s65 offen lds
	v_dot2c_f32_bf16 v10, v132, v8
	v_dot2c_f32_bf16 v12, v132, v132
	v_dot2c_f32_bf16 v11, v133, v8
	v_dot2c_f32_bf16 v13, v133, v133
	s_add_u32 s65, s57, 319488
	s_add_u32 m0, s58, 13312
	s_nop 0
	buffer_load_dwordx4 v200, s[8:11], s65 offen lds
	v_dot2c_f32_bf16 v10, v134, v8
	v_dot2c_f32_bf16 v12, v134, v134
	v_dot2c_f32_bf16 v11, v135, v8
	v_dot2c_f32_bf16 v13, v135, v135
	s_add_u32 s65, s57, 344064
	s_add_u32 m0, s58, 14336
	s_nop 0
	buffer_load_dwordx4 v200, s[8:11], s65 offen lds
	v_dot2c_f32_bf16 v10, v136, v8
	v_dot2c_f32_bf16 v12, v136, v136
	v_dot2c_f32_bf16 v11, v137, v8
	v_dot2c_f32_bf16 v13, v137, v137
	s_add_u32 s65, s57, 368640
	s_add_u32 m0, s58, 15360
	s_nop 0
	buffer_load_dwordx4 v200, s[8:11], s65 offen lds
	v_dot2c_f32_bf16 v10, v138, v8
	v_dot2c_f32_bf16 v12, v138, v138
	v_dot2c_f32_bf16 v11, v139, v8
	v_dot2c_f32_bf16 v13, v139, v139
	v_and_b32 v243, 31, v1
	v_lshlrev_b32 v243, 7, v243
	s_lshl_b32 s55, s49, 2
	s_add_u32 s55, s55, s52
	s_lshl_b32 s56, s55, 12
	v_add_u32 v243, s56, v243
	v_min_u32 v244, 55, v1
	v_mul_u32_u24 v245, 4682, v244
	v_lshrrev_b32 v245, 16, v245
	v_mul_u32_u24 v246, 14, v245
	v_sub_u32 v244, v244, v246
	v_lshlrev_b32 v244, 7, v244
	v_mul_u32_u24 v245, 3584, v245
	v_add_u32 v244, v244, v245
	s_mul_i32 s55, s55, 14336
	s_and_b32 s56, s48, 1
	s_mul_i32 s56, s56, 1792
	s_add_u32 s55, s55, s56
	v_add_u32 v244, s55, v244
	v_and_b32 v245, 31, v1
	v_mul_u32_u24 v245, 6144, v245
	s_lshr_b32 s55, s100, 2
	s_lshl_b32 s55, s55, 7
	s_and_b32 s56, s100, 3
	s_lshl_b32 s56, s56, 2
	s_add_u32 s56, s56, s52
	s_mul_i32 s56, s56, 196608
	s_add_u32 s91, s55, s56
	s_sub_u32 s55, s2, 64
	s_cmp_ge_u32 s55, 128
	s_cselect_b32 s91, 0x7ff00000, s91
	v_dot2c_f32_bf16 v10, v140, v8
	v_dot2c_f32_bf16 v12, v140, v140
	v_dot2c_f32_bf16 v11, v141, v8
	v_dot2c_f32_bf16 v13, v141, v141
	v_dot2c_f32_bf16 v10, v142, v8
	v_dot2c_f32_bf16 v12, v142, v142
	v_dot2c_f32_bf16 v11, v143, v8
	v_dot2c_f32_bf16 v13, v143, v143
	s_nop 1
	v_add_f32 v10, v10, v11
	v_add_f32 v12, v12, v13
	v_mov_b32 v11, v10
	s_nop 1
	v_permlane32_swap_b32 v10, v11
	v_add_f32 v10, v10, v11
	v_mov_b32 v13, v12
	s_nop 1
	v_permlane32_swap_b32 v12, v13
	v_add_f32 v12, v12, v13
	v_mul_f32 v10, 0x3b000000, v10
	v_mul_f32 v12, 0x3b000000, v12
	v_fma_f32 v12, -v10, v10, v12
	v_max_f32 v12, 0, v12
	v_add_f32 v12, 0x3727c5ac, v12
	v_rsq_f32 v223, v12
	v_sub_f32 v10, 0, v10
	v_mul_f32 v11, v12, v223
	v_cvt_pk_bf16_f32 v12, v10, v11
	v_lshlrev_b32 v8, 16, v12
	v_and_b32 v9, s54, v12
	v_sub_f32 v8, v10, v8
	v_sub_f32 v9, v11, v9
	v_cvt_pk_bf16_f32 v13, v8, v9
	s_mov_b32 s55, 0x01000100
	s_mov_b32 s56, 0x03020302
	v_perm_b32 v208, v12, v12, s55
	v_perm_b32 v209, v13, v13, s55
	v_perm_b32 v210, v12, v12, s56
	v_perm_b32 v211, v13, v13, s56
	v_cmp_gt_u32 vcc, 32, v1
	s_nop 1
	v_cndmask_b32 v208, 0, v208, vcc
	v_cndmask_b32 v209, 0, v209, vcc
	v_cndmask_b32 v210, 0, v210, vcc
	v_cndmask_b32 v211, 0, v211, vcc
	v_lshrrev_b32 v8, 5, v1
	v_bfe_u32 v11, v1, 4, 1
	v_bfe_u32 v9, v1, 2, 2
	v_and_b32 v10, 3, v1
	v_lshlrev_b32 v12, 9, v8
	v_lshl_add_u32 v12, v9, 5, v12
	v_lshlrev_b32 v13, 1, v11
	v_lshrrev_b32 v14, 1, v10
	v_add_u32 v13, v13, v14
	v_lshl_add_u32 v12, v13, 3, v12
	v_add_u32 v12, 153600, v12
	v_and_b32 v13, 1, v10
	v_cmp_eq_u32 vcc, v13, v8
	v_add_u32 v14, 0, v12
	v_mov_b32 v15, 154624
	v_cndmask_b32 v14, v15, v14, vcc
	ds_read_b64_tr_b16 a[224:225], v14
	v_add_u32 v14, 128, v12
	v_mov_b32 v15, 154624
	v_cndmask_b32 v14, v15, v14, vcc
	ds_read_b64_tr_b16 a[226:227], v14
	v_add_u32 v14, 256, v12
	v_mov_b32 v15, 154624
	v_cndmask_b32 v14, v15, v14, vcc
	ds_read_b64_tr_b16 a[228:229], v14
	v_add_u32 v14, 384, v12
	v_mov_b32 v15, 154624
	v_cndmask_b32 v14, v15, v14, vcc
	ds_read_b64_tr_b16 a[230:231], v14
	v_and_b32 v8, 31, v1
	v_lshlrev_b32 v8, 2, v8
	s_lshl_b32 s55, s52, 7
	s_add_u32 s55, s55, 159744
	v_add_u32 v8, s55, v8
	ds_write_b32 v8, v223
	v_lshrrev_b32 v9, 5, v1
	v_lshlrev_b32 v9, 4, v9
	v_add_u32 v9, s55, v9
	s_waitcnt lgkmcnt(0)
	ds_read_b128 v[224:227], v9 offset:0
	ds_read_b128 v[228:231], v9 offset:32
	ds_read_b128 v[232:235], v9 offset:64
	ds_read_b128 v[236:239], v9 offset:96
	s_waitcnt lgkmcnt(0)
	s_mov_b32 s64, 200000
	s_waitcnt vmcnt(16)
	s_branch L_modA_chk_7
L_modA_loop_6:
	buffer_load_dwordx4 v[144:147], v202, s[44:47], 0 offen offset:0 sc1
	buffer_load_dwordx4 v[148:151], v203, s[44:47], 0 offen offset:0 sc1
	buffer_load_dwordx4 v[152:155], v204, s[44:47], 0 offen offset:0 sc1
	buffer_load_dwordx4 v[156:159], v205, s[44:47], 0 offen offset:0 sc1
	buffer_load_dwordx4 v[160:163], v206, s[44:47], 0 offen offset:0 sc1
	buffer_load_dwordx4 v[164:167], v207, s[44:47], 0 offen offset:0 sc1
	buffer_load_dwordx4 v[168:171], v241, s[44:47], 0 offen offset:0 sc1
	buffer_load_dwordx4 v[172:175], v242, s[44:47], 0 offen offset:0 sc1
	s_waitcnt vmcnt(0)
L_modA_chk_7:
	v_cmp_ne_u32 vcc, s53, v146
	v_cmp_ne_u32 s[68:69], s53, v150
	s_nop 0
	s_or_b64 vcc, vcc, s[68:69]
	v_cmp_ne_u32 s[68:69], s53, v154
	s_nop 0
	s_or_b64 vcc, vcc, s[68:69]
	v_cmp_ne_u32 s[68:69], s53, v158
	s_nop 0
	s_or_b64 vcc, vcc, s[68:69]
	v_cmp_ne_u32 s[68:69], s53, v162
	s_nop 0
	s_or_b64 vcc, vcc, s[68:69]
	v_cmp_ne_u32 s[68:69], s53, v166
	s_nop 0
	s_or_b64 vcc, vcc, s[68:69]
	v_cmp_ne_u32 s[68:69], s53, v170
	s_nop 0
	s_or_b64 vcc, vcc, s[68:69]
	v_cmp_ne_u32 s[68:69], s53, v174
	s_nop 0
	s_or_b64 vcc, vcc, s[68:69]
	s_cbranch_vccz L_modA_ok_8
	s_sub_u32 s64, s64, 1
	s_cmp_lg_u32 s64, 0
	s_cbranch_scc1 L_modA_loop_6
L_modA_ok_8:
	v_pk_add_f32 v[144:145], v[144:145], v[148:149]
	v_pk_add_f32 v[152:153], v[152:153], v[156:157]
	v_pk_add_f32 v[144:145], v[144:145], v[152:153]
	v_pk_add_f32 v[160:161], v[160:161], v[164:165]
	v_pk_add_f32 v[168:169], v[168:169], v[172:173]
	v_pk_add_f32 v[160:161], v[160:161], v[168:169]
	v_cvt_pk_bf16_f32 v204, v144, v145
	v_cvt_pk_bf16_f32 v206, v160, v161
	v_lshlrev_b32 v192, 16, v206
	v_and_b32 v193, s54, v206
	v_add_f32 v192, 1.0, v192
	v_add_f32 v193, 1.0, v193
	v_cvt_pk_bf16_f32 v12, v192, v193
	v_and_b32 v192, 0xffff, v12
	v_and_b32 v194, 0xffff, v204
	v_and_b32 v196, s54, v12
	v_and_b32 v198, s54, v204
	v_mov_b32 v193, v192
	v_mov_b32 v195, v194
	v_mov_b32 v197, v196
	v_mov_b32 v199, v198
	v_lshlrev_b32 v8, 5, v0
	v_add_u32 v8, 139264, v8
	ds_write_b128 v8, v[192:195]
	ds_write_b128 v8, v[196:199] offset:16
	s_waitcnt vmcnt(0)
	s_waitcnt lgkmcnt(0)
	s_barrier
	s_mul_i32 s58, s52, 393216
	s_lshl_b32 s59, s52, 13
	s_add_u32 s59, s59, 65536
	ds_read_b128 v[200:203], v222 offset:0
	ds_read_b128 v[204:207], v222 offset:512
	ds_read_b64_tr_b16 a[0:1], v220 offset:0
	ds_read_b64_tr_b16 a[2:3], v220 offset:1024
	ds_read_b64_tr_b16 a[4:5], v221 offset:0
	ds_read_b64_tr_b16 a[6:7], v221 offset:1024
	ds_read_b64_tr_b16 a[8:9], v220 offset:2048
	ds_read_b64_tr_b16 a[10:11], v220 offset:3072
	ds_read_b64_tr_b16 a[12:13], v221 offset:2048
	ds_read_b64_tr_b16 a[14:15], v221 offset:3072
	s_waitcnt lgkmcnt(9)
	v_and_b32 v192, v200, v212
	v_and_b32 v193, v200, v213
	v_and_b32 v194, v200, v214
	v_and_b32 v195, v200, v215
	v_and_b32 v196, v200, v216
	v_and_b32 v197, v200, v217
	v_and_b32 v198, v200, v218
	v_and_b32 v199, v200, v219
	v_mfma_f32_32x32x16_bf16 v[144:159], v[192:195], v[16:19], 0
	s_nop 0
	v_mfma_f32_32x32x16_bf16 v[144:159], v[196:199], v[20:23], v[144:159]
	v_mfma_f32_32x32x16_bf16 v[144:159], v[200:203], v[208:211], v[144:159]
	s_waitcnt lgkmcnt(8)
	v_and_b32 v192, v204, v212
	v_and_b32 v193, v204, v213
	v_and_b32 v194, v204, v214
	v_and_b32 v195, v204, v215
	v_and_b32 v196, v204, v216
	v_and_b32 v197, v204, v217
	v_and_b32 v198, v204, v218
	v_and_b32 v199, v204, v219
	s_nop 2
	v_cvt_pk_bf16_f32 v16, v144, v145
	v_cvt_pk_bf16_f32 v17, v146, v147
	v_cvt_pk_bf16_f32 v18, v148, v149
	v_cvt_pk_bf16_f32 v19, v150, v151
	v_cvt_pk_bf16_f32 v20, v152, v153
	v_cvt_pk_bf16_f32 v21, v154, v155
	v_cvt_pk_bf16_f32 v22, v156, v157
	v_cvt_pk_bf16_f32 v23, v158, v159
	v_mfma_f32_32x32x16_bf16 v[144:159], v[192:195], v[24:27], 0
	ds_read_b128 v[200:203], v222 offset:1024
	ds_read_b64_tr_b16 a[16:17], v220 offset:4096
	v_mfma_f32_32x32x16_bf16 v[144:159], v[196:199], v[28:31], v[144:159]
	ds_read_b64_tr_b16 a[18:19], v220 offset:5120
	ds_read_b64_tr_b16 a[20:21], v221 offset:4096
	ds_read_b64_tr_b16 a[22:23], v221 offset:5120
	v_mfma_f32_32x32x16_bf16 v[144:159], v[204:207], v[208:211], v[144:159]
	ds_read_b64_tr_b16 a[24:25], v220 offset:6144
	ds_read_b64_tr_b16 a[26:27], v220 offset:7168
	ds_read_b64_tr_b16 a[28:29], v221 offset:6144
	s_waitcnt lgkmcnt(14)
	v_mfma_f32_32x32x16_bf16 v[160:175], a[0:3], v[16:19], 0
	ds_read_b64_tr_b16 a[30:31], v221 offset:7168
	s_waitcnt lgkmcnt(8)
	v_and_b32 v192, v200, v212
	v_and_b32 v193, v200, v213
	v_and_b32 v194, v200, v214
	v_mfma_f32_32x32x16_bf16 v[176:191], v[16:19], a[4:7], 0
	v_and_b32 v195, v200, v215
	v_and_b32 v196, v200, v216
	v_and_b32 v197, v200, v217
	v_and_b32 v198, v200, v218
	v_and_b32 v199, v200, v219
	v_mfma_f32_32x32x16_bf16 v[160:175], a[8:11], v[20:23], v[160:175]
	v_cvt_pk_bf16_f32 v24, v144, v145
	v_cvt_pk_bf16_f32 v25, v146, v147
	v_cvt_pk_bf16_f32 v26, v148, v149
	v_cvt_pk_bf16_f32 v27, v150, v151
	v_mfma_f32_32x32x16_bf16 v[176:191], v[20:23], a[12:15], v[176:191]
	v_cvt_pk_bf16_f32 v28, v152, v153
	v_cvt_pk_bf16_f32 v29, v154, v155
	v_cvt_pk_bf16_f32 v30, v156, v157
	v_cvt_pk_bf16_f32 v31, v158, v159
	s_add_u32 s65, s58, 0
	s_add_u32 m0, s59, 0
	s_nop 0
	buffer_load_dwordx4 v6, s[8:11], s65 offen lds
	s_add_u32 s65, s58, 49152
	s_add_u32 m0, s59, 1024
	s_nop 0
	buffer_load_dwordx4 v6, s[8:11], s65 offen lds
	v_mfma_f32_32x32x16_bf16 v[144:159], v[192:195], v[32:35], 0
	ds_read_b128 v[204:207], v222 offset:1536
	ds_read_b64_tr_b16 a[0:1], v220 offset:8192
	v_mfma_f32_32x32x16_bf16 v[144:159], v[196:199], v[36:39], v[144:159]
	ds_read_b64_tr_b16 a[2:3], v220 offset:9216
	ds_read_b64_tr_b16 a[4:5], v221 offset:8192
	ds_read_b64_tr_b16 a[6:7], v221 offset:9216
	v_mfma_f32_32x32x16_bf16 v[144:159], v[200:203], v[208:211], v[144:159]
	ds_read_b64_tr_b16 a[8:9], v220 offset:10240
	ds_read_b64_tr_b16 a[10:11], v220 offset:11264
	ds_read_b64_tr_b16 a[12:13], v221 offset:10240
	s_waitcnt lgkmcnt(14)
	v_mfma_f32_32x32x16_bf16 v[160:175], a[16:19], v[24:27], v[160:175]
	ds_read_b64_tr_b16 a[14:15], v221 offset:11264
	s_waitcnt lgkmcnt(8)
	v_and_b32 v192, v204, v212
	v_and_b32 v193, v204, v213
	v_and_b32 v194, v204, v214
	v_mfma_f32_32x32x16_bf16 v[176:191], v[24:27], a[20:23], v[176:191]
	v_and_b32 v195, v204, v215
	v_and_b32 v196, v204, v216
	v_and_b32 v197, v204, v217
	v_and_b32 v198, v204, v218
	v_and_b32 v199, v204, v219
	v_mfma_f32_32x32x16_bf16 v[160:175], a[24:27], v[28:31], v[160:175]
	v_cvt_pk_bf16_f32 v32, v144, v145
	v_cvt_pk_bf16_f32 v33, v146, v147
	v_cvt_pk_bf16_f32 v34, v148, v149
	v_cvt_pk_bf16_f32 v35, v150, v151
	v_mfma_f32_32x32x16_bf16 v[176:191], v[28:31], a[28:31], v[176:191]
	v_cvt_pk_bf16_f32 v36, v152, v153
	v_cvt_pk_bf16_f32 v37, v154, v155
	v_cvt_pk_bf16_f32 v38, v156, v157
	v_cvt_pk_bf16_f32 v39, v158, v159
	s_add_u32 s65, s58, 98304
	s_add_u32 m0, s59, 2048
	s_nop 0
	buffer_load_dwordx4 v6, s[8:11], s65 offen lds
	s_add_u32 s65, s58, 147456
	s_add_u32 m0, s59, 3072
	s_nop 0
	buffer_load_dwordx4 v6, s[8:11], s65 offen lds
	v_mfma_f32_32x32x16_bf16 v[144:159], v[192:195], v[40:43], 0
	ds_read_b128 v[200:203], v222 offset:2048
	ds_read_b64_tr_b16 a[16:17], v220 offset:12288
	v_mfma_f32_32x32x16_bf16 v[144:159], v[196:199], v[44:47], v[144:159]
	ds_read_b64_tr_b16 a[18:19], v220 offset:13312
	ds_read_b64_tr_b16 a[20:21], v221 offset:12288
	ds_read_b64_tr_b16 a[22:23], v221 offset:13312
	v_mfma_f32_32x32x16_bf16 v[144:159], v[204:207], v[208:211], v[144:159]
	ds_read_b64_tr_b16 a[24:25], v220 offset:14336
	ds_read_b64_tr_b16 a[26:27], v220 offset:15360
	ds_read_b64_tr_b16 a[28:29], v221 offset:14336
	s_waitcnt lgkmcnt(14)
	v_mfma_f32_32x32x16_bf16 v[160:175], a[0:3], v[32:35], v[160:175]
	ds_read_b64_tr_b16 a[30:31], v221 offset:15360
	s_waitcnt lgkmcnt(8)
	v_and_b32 v192, v200, v212
	v_and_b32 v193, v200, v213
	v_and_b32 v194, v200, v214
	v_mfma_f32_32x32x16_bf16 v[176:191], v[32:35], a[4:7], v[176:191]
	v_and_b32 v195, v200, v215
	v_and_b32 v196, v200, v216
	v_and_b32 v197, v200, v217
	v_and_b32 v198, v200, v218
	v_and_b32 v199, v200, v219
	v_mfma_f32_32x32x16_bf16 v[160:175], a[8:11], v[36:39], v[160:175]
	v_cvt_pk_bf16_f32 v40, v144, v145
	v_cvt_pk_bf16_f32 v41, v146, v147
	v_cvt_pk_bf16_f32 v42, v148, v149
	v_cvt_pk_bf16_f32 v43, v150, v151
	v_mfma_f32_32x32x16_bf16 v[176:191], v[36:39], a[12:15], v[176:191]
	v_cvt_pk_bf16_f32 v44, v152, v153
	v_cvt_pk_bf16_f32 v45, v154, v155
	v_cvt_pk_bf16_f32 v46, v156, v157
	v_cvt_pk_bf16_f32 v47, v158, v159
	s_add_u32 s65, s58, 196608
	s_add_u32 m0, s59, 4096
	s_nop 0
	buffer_load_dwordx4 v6, s[8:11], s65 offen lds
	s_add_u32 s65, s58, 245760
	s_add_u32 m0, s59, 5120
	s_nop 0
	buffer_load_dwordx4 v6, s[8:11], s65 offen lds
	v_mfma_f32_32x32x16_bf16 v[144:159], v[192:195], v[48:51], 0
	ds_read_b128 v[204:207], v222 offset:2560
	ds_read_b64_tr_b16 a[0:1], v220 offset:16384
	v_mfma_f32_32x32x16_bf16 v[144:159], v[196:199], v[52:55], v[144:159]
	ds_read_b64_tr_b16 a[2:3], v220 offset:17408
	ds_read_b64_tr_b16 a[4:5], v221 offset:16384
	ds_read_b64_tr_b16 a[6:7], v221 offset:17408
	v_mfma_f32_32x32x16_bf16 v[144:159], v[200:203], v[208:211], v[144:159]
	ds_read_b64_tr_b16 a[8:9], v220 offset:18432
	ds_read_b64_tr_b16 a[10:11], v220 offset:19456
	ds_read_b64_tr_b16 a[12:13], v221 offset:18432
	s_waitcnt lgkmcnt(14)
	v_mfma_f32_32x32x16_bf16 v[160:175], a[16:19], v[40:43], v[160:175]
	ds_read_b64_tr_b16 a[14:15], v221 offset:19456
	s_waitcnt lgkmcnt(8)
	v_and_b32 v192, v204, v212
	v_and_b32 v193, v204, v213
	v_and_b32 v194, v204, v214
	v_mfma_f32_32x32x16_bf16 v[176:191], v[40:43], a[20:23], v[176:191]
	v_and_b32 v195, v204, v215
	v_and_b32 v196, v204, v216
	v_and_b32 v197, v204, v217
	v_and_b32 v198, v204, v218
	v_and_b32 v199, v204, v219
	v_mfma_f32_32x32x16_bf16 v[160:175], a[24:27], v[44:47], v[160:175]
	v_cvt_pk_bf16_f32 v48, v144, v145
	v_cvt_pk_bf16_f32 v49, v146, v147
	v_cvt_pk_bf16_f32 v50, v148, v149
	v_cvt_pk_bf16_f32 v51, v150, v151
	v_mfma_f32_32x32x16_bf16 v[176:191], v[44:47], a[28:31], v[176:191]
	v_cvt_pk_bf16_f32 v52, v152, v153
	v_cvt_pk_bf16_f32 v53, v154, v155
	v_cvt_pk_bf16_f32 v54, v156, v157
	v_cvt_pk_bf16_f32 v55, v158, v159
	s_add_u32 s65, s58, 294912
	s_add_u32 m0, s59, 6144
	s_nop 0
	buffer_load_dwordx4 v6, s[8:11], s65 offen lds
	s_add_u32 s65, s58, 344064
	s_add_u32 m0, s59, 7168
	s_nop 0
	buffer_load_dwordx4 v6, s[8:11], s65 offen lds
	v_mfma_f32_32x32x16_bf16 v[144:159], v[192:195], v[56:59], 0
	ds_read_b128 v[200:203], v222 offset:3072
	ds_read_b64_tr_b16 a[16:17], v220 offset:20480
	v_mfma_f32_32x32x16_bf16 v[144:159], v[196:199], v[60:63], v[144:159]
	ds_read_b64_tr_b16 a[18:19], v220 offset:21504
	ds_read_b64_tr_b16 a[20:21], v221 offset:20480
	ds_read_b64_tr_b16 a[22:23], v221 offset:21504
	v_mfma_f32_32x32x16_bf16 v[144:159], v[204:207], v[208:211], v[144:159]
	ds_read_b64_tr_b16 a[24:25], v220 offset:22528
	ds_read_b64_tr_b16 a[26:27], v220 offset:23552
	ds_read_b64_tr_b16 a[28:29], v221 offset:22528
	s_waitcnt lgkmcnt(14)
	v_mfma_f32_32x32x16_bf16 v[160:175], a[0:3], v[48:51], v[160:175]
	ds_read_b64_tr_b16 a[30:31], v221 offset:23552
	s_waitcnt lgkmcnt(8)
	v_and_b32 v192, v200, v212
	v_and_b32 v193, v200, v213
	v_and_b32 v194, v200, v214
	v_mfma_f32_32x32x16_bf16 v[176:191], v[48:51], a[4:7], v[176:191]
	v_and_b32 v195, v200, v215
	v_and_b32 v196, v200, v216
	v_and_b32 v197, v200, v217
	v_and_b32 v198, v200, v218
	v_and_b32 v199, v200, v219
	v_mfma_f32_32x32x16_bf16 v[160:175], a[8:11], v[52:55], v[160:175]
	v_cvt_pk_bf16_f32 v56, v144, v145
	v_cvt_pk_bf16_f32 v57, v146, v147
	v_cvt_pk_bf16_f32 v58, v148, v149
	v_cvt_pk_bf16_f32 v59, v150, v151
	v_mfma_f32_32x32x16_bf16 v[176:191], v[52:55], a[12:15], v[176:191]
	v_cvt_pk_bf16_f32 v60, v152, v153
	v_cvt_pk_bf16_f32 v61, v154, v155
	v_cvt_pk_bf16_f32 v62, v156, v157
	v_cvt_pk_bf16_f32 v63, v158, v159
	buffer_load_dword v5, v245, s[36:39], s91 offen
	v_mfma_f32_32x32x16_bf16 v[144:159], v[192:195], v[64:67], 0
	ds_read_b128 v[204:207], v222 offset:3584
	ds_read_b64_tr_b16 a[0:1], v220 offset:24576
	v_mfma_f32_32x32x16_bf16 v[144:159], v[196:199], v[68:71], v[144:159]
	ds_read_b64_tr_b16 a[2:3], v220 offset:25600
	ds_read_b64_tr_b16 a[4:5], v221 offset:24576
	ds_read_b64_tr_b16 a[6:7], v221 offset:25600
	v_mfma_f32_32x32x16_bf16 v[144:159], v[200:203], v[208:211], v[144:159]
	ds_read_b64_tr_b16 a[8:9], v220 offset:26624
	ds_read_b64_tr_b16 a[10:11], v220 offset:27648
	ds_read_b64_tr_b16 a[12:13], v221 offset:26624
	s_waitcnt lgkmcnt(14)
	v_mfma_f32_32x32x16_bf16 v[160:175], a[16:19], v[56:59], v[160:175]
	ds_read_b64_tr_b16 a[14:15], v221 offset:27648
	s_waitcnt lgkmcnt(8)
	v_and_b32 v192, v204, v212
	v_and_b32 v193, v204, v213
	v_and_b32 v194, v204, v214
	v_mfma_f32_32x32x16_bf16 v[176:191], v[56:59], a[20:23], v[176:191]
	v_and_b32 v195, v204, v215
	v_and_b32 v196, v204, v216
	v_and_b32 v197, v204, v217
	v_and_b32 v198, v204, v218
	v_and_b32 v199, v204, v219
	v_mfma_f32_32x32x16_bf16 v[160:175], a[24:27], v[60:63], v[160:175]
	v_cvt_pk_bf16_f32 v64, v144, v145
	v_cvt_pk_bf16_f32 v65, v146, v147
	v_cvt_pk_bf16_f32 v66, v148, v149
	v_cvt_pk_bf16_f32 v67, v150, v151
	v_mfma_f32_32x32x16_bf16 v[176:191], v[60:63], a[28:31], v[176:191]
	v_cvt_pk_bf16_f32 v68, v152, v153
	v_cvt_pk_bf16_f32 v69, v154, v155
	v_cvt_pk_bf16_f32 v70, v156, v157
	v_cvt_pk_bf16_f32 v71, v158, v159
	buffer_load_dword v5, v243, s[16:19], 0 offen
	v_mfma_f32_32x32x16_bf16 v[144:159], v[192:195], v[72:75], 0
	ds_read_b128 v[200:203], v222 offset:4096
	ds_read_b64_tr_b16 a[16:17], v220 offset:28672
	v_mfma_f32_32x32x16_bf16 v[144:159], v[196:199], v[76:79], v[144:159]
	ds_read_b64_tr_b16 a[18:19], v220 offset:29696
	ds_read_b64_tr_b16 a[20:21], v221 offset:28672
	ds_read_b64_tr_b16 a[22:23], v221 offset:29696
	v_mfma_f32_32x32x16_bf16 v[144:159], v[204:207], v[208:211], v[144:159]
	ds_read_b64_tr_b16 a[24:25], v220 offset:30720
	ds_read_b64_tr_b16 a[26:27], v220 offset:31744
	ds_read_b64_tr_b16 a[28:29], v221 offset:30720
	s_waitcnt lgkmcnt(14)
	v_mfma_f32_32x32x16_bf16 v[160:175], a[0:3], v[64:67], v[160:175]
	ds_read_b64_tr_b16 a[30:31], v221 offset:31744
	s_waitcnt lgkmcnt(8)
	v_and_b32 v192, v200, v212
	v_and_b32 v193, v200, v213
	v_and_b32 v194, v200, v214
	v_mfma_f32_32x32x16_bf16 v[176:191], v[64:67], a[4:7], v[176:191]
	v_and_b32 v195, v200, v215
	v_and_b32 v196, v200, v216
	v_and_b32 v197, v200, v217
	v_and_b32 v198, v200, v218
	v_and_b32 v199, v200, v219
	v_mfma_f32_32x32x16_bf16 v[160:175], a[8:11], v[68:71], v[160:175]
	v_cvt_pk_bf16_f32 v72, v144, v145
	v_cvt_pk_bf16_f32 v73, v146, v147
	v_cvt_pk_bf16_f32 v74, v148, v149
	v_cvt_pk_bf16_f32 v75, v150, v151
	v_mfma_f32_32x32x16_bf16 v[176:191], v[68:71], a[12:15], v[176:191]
	v_cvt_pk_bf16_f32 v76, v152, v153
	v_cvt_pk_bf16_f32 v77, v154, v155
	v_cvt_pk_bf16_f32 v78, v156, v157
	v_cvt_pk_bf16_f32 v79, v158, v159
	buffer_load_dword v5, v244, s[20:23], 0 offen
	v_mfma_f32_32x32x16_bf16 v[144:159], v[192:195], v[80:83], 0
	ds_read_b128 v[204:207], v222 offset:4608
	ds_read_b64_tr_b16 a[0:1], v220 offset:32768
	v_mfma_f32_32x32x16_bf16 v[144:159], v[196:199], v[84:87], v[144:159]
	ds_read_b64_tr_b16 a[2:3], v220 offset:33792
	ds_read_b64_tr_b16 a[4:5], v221 offset:32768
	ds_read_b64_tr_b16 a[6:7], v221 offset:33792
	v_mfma_f32_32x32x16_bf16 v[144:159], v[200:203], v[208:211], v[144:159]
	ds_read_b64_tr_b16 a[8:9], v220 offset:34816
	ds_read_b64_tr_b16 a[10:11], v220 offset:35840
	ds_read_b64_tr_b16 a[12:13], v221 offset:34816
	s_waitcnt lgkmcnt(14)
	v_mfma_f32_32x32x16_bf16 v[160:175], a[16:19], v[72:75], v[160:175]
	ds_read_b64_tr_b16 a[14:15], v221 offset:35840
	s_waitcnt lgkmcnt(8)
	v_and_b32 v192, v204, v212
	v_and_b32 v193, v204, v213
	v_and_b32 v194, v204, v214
	v_mfma_f32_32x32x16_bf16 v[176:191], v[72:75], a[20:23], v[176:191]
	v_and_b32 v195, v204, v215
	v_and_b32 v196, v204, v216
	v_and_b32 v197, v204, v217
	v_and_b32 v198, v204, v218
	v_and_b32 v199, v204, v219
	v_mfma_f32_32x32x16_bf16 v[160:175], a[24:27], v[76:79], v[160:175]
	v_cvt_pk_bf16_f32 v80, v144, v145
	v_cvt_pk_bf16_f32 v81, v146, v147
	v_cvt_pk_bf16_f32 v82, v148, v149
	v_cvt_pk_bf16_f32 v83, v150, v151
	v_mfma_f32_32x32x16_bf16 v[176:191], v[76:79], a[28:31], v[176:191]
	v_cvt_pk_bf16_f32 v84, v152, v153
	v_cvt_pk_bf16_f32 v85, v154, v155
	v_cvt_pk_bf16_f32 v86, v156, v157
	v_cvt_pk_bf16_f32 v87, v158, v159
	buffer_load_dword v5, v244, s[24:27], 0 offen
	v_mfma_f32_32x32x16_bf16 v[144:159], v[192:195], v[88:91], 0
	ds_read_b128 v[200:203], v222 offset:5120
	ds_read_b64_tr_b16 a[16:17], v220 offset:36864
	v_mfma_f32_32x32x16_bf16 v[144:159], v[196:199], v[92:95], v[144:159]
	ds_read_b64_tr_b16 a[18:19], v220 offset:37888
	ds_read_b64_tr_b16 a[20:21], v221 offset:36864
	ds_read_b64_tr_b16 a[22:23], v221 offset:37888
	v_mfma_f32_32x32x16_bf16 v[144:159], v[204:207], v[208:211], v[144:159]
	ds_read_b64_tr_b16 a[24:25], v220 offset:38912
	ds_read_b64_tr_b16 a[26:27], v220 offset:39936
	ds_read_b64_tr_b16 a[28:29], v221 offset:38912
	s_waitcnt lgkmcnt(14)
	v_mfma_f32_32x32x16_bf16 v[160:175], a[0:3], v[80:83], v[160:175]
	ds_read_b64_tr_b16 a[30:31], v221 offset:39936
	s_waitcnt lgkmcnt(8)
	v_and_b32 v192, v200, v212
	v_and_b32 v193, v200, v213
	v_and_b32 v194, v200, v214
	v_mfma_f32_32x32x16_bf16 v[176:191], v[80:83], a[4:7], v[176:191]
	v_and_b32 v195, v200, v215
	v_and_b32 v196, v200, v216
	v_and_b32 v197, v200, v217
	v_and_b32 v198, v200, v218
	v_and_b32 v199, v200, v219
	v_mfma_f32_32x32x16_bf16 v[160:175], a[8:11], v[84:87], v[160:175]
	v_cvt_pk_bf16_f32 v88, v144, v145
	v_cvt_pk_bf16_f32 v89, v146, v147
	v_cvt_pk_bf16_f32 v90, v148, v149
	v_cvt_pk_bf16_f32 v91, v150, v151
	v_mfma_f32_32x32x16_bf16 v[176:191], v[84:87], a[12:15], v[176:191]
	v_cvt_pk_bf16_f32 v92, v152, v153
	v_cvt_pk_bf16_f32 v93, v154, v155
	v_cvt_pk_bf16_f32 v94, v156, v157
	v_cvt_pk_bf16_f32 v95, v158, v159
	v_mfma_f32_32x32x16_bf16 v[144:159], v[192:195], v[96:99], 0
	ds_read_b128 v[204:207], v222 offset:5632
	ds_read_b64_tr_b16 a[0:1], v220 offset:40960
	v_mfma_f32_32x32x16_bf16 v[144:159], v[196:199], v[100:103], v[144:159]
	ds_read_b64_tr_b16 a[2:3], v220 offset:41984
	ds_read_b64_tr_b16 a[4:5], v221 offset:40960
	ds_read_b64_tr_b16 a[6:7], v221 offset:41984
	v_mfma_f32_32x32x16_bf16 v[144:159], v[200:203], v[208:211], v[144:159]
	ds_read_b64_tr_b16 a[8:9], v220 offset:43008
	ds_read_b64_tr_b16 a[10:11], v220 offset:44032
	ds_read_b64_tr_b16 a[12:13], v221 offset:43008
	s_waitcnt lgkmcnt(14)
	v_mfma_f32_32x32x16_bf16 v[160:175], a[16:19], v[88:91], v[160:175]
	ds_read_b64_tr_b16 a[14:15], v221 offset:44032
	s_waitcnt lgkmcnt(8)
	v_and_b32 v192, v204, v212
	v_and_b32 v193, v204, v213
	v_and_b32 v194, v204, v214
	v_mfma_f32_32x32x16_bf16 v[176:191], v[88:91], a[20:23], v[176:191]
	v_and_b32 v195, v204, v215
	v_and_b32 v196, v204, v216
	v_and_b32 v197, v204, v217
	v_and_b32 v198, v204, v218
	v_and_b32 v199, v204, v219
	v_mfma_f32_32x32x16_bf16 v[160:175], a[24:27], v[92:95], v[160:175]
	v_cvt_pk_bf16_f32 v96, v144, v145
	v_cvt_pk_bf16_f32 v97, v146, v147
	v_cvt_pk_bf16_f32 v98, v148, v149
	v_cvt_pk_bf16_f32 v99, v150, v151
	v_mfma_f32_32x32x16_bf16 v[176:191], v[92:95], a[28:31], v[176:191]
	v_cvt_pk_bf16_f32 v100, v152, v153
	v_cvt_pk_bf16_f32 v101, v154, v155
	v_cvt_pk_bf16_f32 v102, v156, v157
	v_cvt_pk_bf16_f32 v103, v158, v159
	v_mfma_f32_32x32x16_bf16 v[144:159], v[192:195], v[104:107], 0
	ds_read_b128 v[200:203], v222 offset:6144
	ds_read_b64_tr_b16 a[16:17], v220 offset:45056
	v_mfma_f32_32x32x16_bf16 v[144:159], v[196:199], v[108:111], v[144:159]
	ds_read_b64_tr_b16 a[18:19], v220 offset:46080
	ds_read_b64_tr_b16 a[20:21], v221 offset:45056
	ds_read_b64_tr_b16 a[22:23], v221 offset:46080
	v_mfma_f32_32x32x16_bf16 v[144:159], v[204:207], v[208:211], v[144:159]
	ds_read_b64_tr_b16 a[24:25], v220 offset:47104
	ds_read_b64_tr_b16 a[26:27], v220 offset:48128
	ds_read_b64_tr_b16 a[28:29], v221 offset:47104
	s_waitcnt lgkmcnt(14)
	v_mfma_f32_32x32x16_bf16 v[160:175], a[0:3], v[96:99], v[160:175]
	ds_read_b64_tr_b16 a[30:31], v221 offset:48128
	s_waitcnt lgkmcnt(8)
	v_and_b32 v192, v200, v212
	v_and_b32 v193, v200, v213
	v_and_b32 v194, v200, v214
	v_mfma_f32_32x32x16_bf16 v[176:191], v[96:99], a[4:7], v[176:191]
	v_and_b32 v195, v200, v215
	v_and_b32 v196, v200, v216
	v_and_b32 v197, v200, v217
	v_and_b32 v198, v200, v218
	v_and_b32 v199, v200, v219
	v_mfma_f32_32x32x16_bf16 v[160:175], a[8:11], v[100:103], v[160:175]
	v_cvt_pk_bf16_f32 v104, v144, v145
	v_cvt_pk_bf16_f32 v105, v146, v147
	v_cvt_pk_bf16_f32 v106, v148, v149
	v_cvt_pk_bf16_f32 v107, v150, v151
	v_mfma_f32_32x32x16_bf16 v[176:191], v[100:103], a[12:15], v[176:191]
	v_cvt_pk_bf16_f32 v108, v152, v153
	v_cvt_pk_bf16_f32 v109, v154, v155
	v_cvt_pk_bf16_f32 v110, v156, v157
	v_cvt_pk_bf16_f32 v111, v158, v159
	v_mfma_f32_32x32x16_bf16 v[144:159], v[192:195], v[112:115], 0
	ds_read_b128 v[204:207], v222 offset:6656
	ds_read_b64_tr_b16 a[0:1], v220 offset:49152
	v_mfma_f32_32x32x16_bf16 v[144:159], v[196:199], v[116:119], v[144:159]
	ds_read_b64_tr_b16 a[2:3], v220 offset:50176
	ds_read_b64_tr_b16 a[4:5], v221 offset:49152
	ds_read_b64_tr_b16 a[6:7], v221 offset:50176
	v_mfma_f32_32x32x16_bf16 v[144:159], v[200:203], v[208:211], v[144:159]
	ds_read_b64_tr_b16 a[8:9], v220 offset:51200
	ds_read_b64_tr_b16 a[10:11], v220 offset:52224
	ds_read_b64_tr_b16 a[12:13], v221 offset:51200
	s_waitcnt lgkmcnt(14)
	v_mfma_f32_32x32x16_bf16 v[160:175], a[16:19], v[104:107], v[160:175]
	ds_read_b64_tr_b16 a[14:15], v221 offset:52224
	s_waitcnt lgkmcnt(8)
	v_and_b32 v192, v204, v212
	v_and_b32 v193, v204, v213
	v_and_b32 v194, v204, v214
	v_mfma_f32_32x32x16_bf16 v[176:191], v[104:107], a[20:23], v[176:191]
	v_and_b32 v195, v204, v215
	v_and_b32 v196, v204, v216
	v_and_b32 v197, v204, v217
	v_and_b32 v198, v204, v218
	v_and_b32 v199, v204, v219
	v_mfma_f32_32x32x16_bf16 v[160:175], a[24:27], v[108:111], v[160:175]
	v_cvt_pk_bf16_f32 v112, v144, v145
	v_cvt_pk_bf16_f32 v113, v146, v147
	v_cvt_pk_bf16_f32 v114, v148, v149
	v_cvt_pk_bf16_f32 v115, v150, v151
	v_mfma_f32_32x32x16_bf16 v[176:191], v[108:111], a[28:31], v[176:191]
	v_cvt_pk_bf16_f32 v116, v152, v153
	v_cvt_pk_bf16_f32 v117, v154, v155
	v_cvt_pk_bf16_f32 v118, v156, v157
	v_cvt_pk_bf16_f32 v119, v158, v159
	v_mfma_f32_32x32x16_bf16 v[144:159], v[192:195], v[120:123], 0
	ds_read_b128 v[200:203], v222 offset:7168
	ds_read_b64_tr_b16 a[16:17], v220 offset:53248
	v_mfma_f32_32x32x16_bf16 v[144:159], v[196:199], v[124:127], v[144:159]
	ds_read_b64_tr_b16 a[18:19], v220 offset:54272
	ds_read_b64_tr_b16 a[20:21], v221 offset:53248
	ds_read_b64_tr_b16 a[22:23], v221 offset:54272
	v_mfma_f32_32x32x16_bf16 v[144:159], v[204:207], v[208:211], v[144:159]
	ds_read_b64_tr_b16 a[24:25], v220 offset:55296
	ds_read_b64_tr_b16 a[26:27], v220 offset:56320
	ds_read_b64_tr_b16 a[28:29], v221 offset:55296
	s_waitcnt lgkmcnt(14)
	v_mfma_f32_32x32x16_bf16 v[160:175], a[0:3], v[112:115], v[160:175]
	ds_read_b64_tr_b16 a[30:31], v221 offset:56320
	s_waitcnt lgkmcnt(8)
	v_and_b32 v192, v200, v212
	v_and_b32 v193, v200, v213
	v_and_b32 v194, v200, v214
	v_mfma_f32_32x32x16_bf16 v[176:191], v[112:115], a[4:7], v[176:191]
	v_and_b32 v195, v200, v215
	v_and_b32 v196, v200, v216
	v_and_b32 v197, v200, v217
	v_and_b32 v198, v200, v218
	v_and_b32 v199, v200, v219
	v_mfma_f32_32x32x16_bf16 v[160:175], a[8:11], v[116:119], v[160:175]
	v_cvt_pk_bf16_f32 v120, v144, v145
	v_cvt_pk_bf16_f32 v121, v146, v147
	v_cvt_pk_bf16_f32 v122, v148, v149
	v_cvt_pk_bf16_f32 v123, v150, v151
	v_mfma_f32_32x32x16_bf16 v[176:191], v[116:119], a[12:15], v[176:191]
	v_cvt_pk_bf16_f32 v124, v152, v153
	v_cvt_pk_bf16_f32 v125, v154, v155
	v_cvt_pk_bf16_f32 v126, v156, v157
	v_cvt_pk_bf16_f32 v127, v158, v159
	v_mfma_f32_32x32x16_bf16 v[144:159], v[192:195], v[128:131], 0
	ds_read_b128 v[204:207], v222 offset:7680
	ds_read_b64_tr_b16 a[0:1], v220 offset:57344
	v_mfma_f32_32x32x16_bf16 v[144:159], v[196:199], v[132:135], v[144:159]
	ds_read_b64_tr_b16 a[2:3], v220 offset:58368
	ds_read_b64_tr_b16 a[4:5], v221 offset:57344
	ds_read_b64_tr_b16 a[6:7], v221 offset:58368
	v_mfma_f32_32x32x16_bf16 v[144:159], v[200:203], v[208:211], v[144:159]
	ds_read_b64_tr_b16 a[8:9], v220 offset:59392
	ds_read_b64_tr_b16 a[10:11], v220 offset:60416
	ds_read_b64_tr_b16 a[12:13], v221 offset:59392
	s_waitcnt lgkmcnt(14)
	v_mfma_f32_32x32x16_bf16 v[160:175], a[16:19], v[120:123], v[160:175]
	ds_read_b64_tr_b16 a[14:15], v221 offset:60416
	s_waitcnt lgkmcnt(8)
	v_and_b32 v192, v204, v212
	v_and_b32 v193, v204, v213
	v_and_b32 v194, v204, v214
	v_mfma_f32_32x32x16_bf16 v[176:191], v[120:123], a[20:23], v[176:191]
	v_and_b32 v195, v204, v215
	v_and_b32 v196, v204, v216
	v_and_b32 v197, v204, v217
	v_and_b32 v198, v204, v218
	v_and_b32 v199, v204, v219
	v_mfma_f32_32x32x16_bf16 v[160:175], a[24:27], v[124:127], v[160:175]
	v_cvt_pk_bf16_f32 v128, v144, v145
	v_cvt_pk_bf16_f32 v129, v146, v147
	v_cvt_pk_bf16_f32 v130, v148, v149
	v_cvt_pk_bf16_f32 v131, v150, v151
	v_mfma_f32_32x32x16_bf16 v[176:191], v[124:127], a[28:31], v[176:191]
	v_cvt_pk_bf16_f32 v132, v152, v153
	v_cvt_pk_bf16_f32 v133, v154, v155
	v_cvt_pk_bf16_f32 v134, v156, v157
	v_cvt_pk_bf16_f32 v135, v158, v159
	v_mfma_f32_32x32x16_bf16 v[144:159], v[192:195], v[136:139], 0
	ds_read_b64_tr_b16 a[16:17], v220 offset:61440
	v_mfma_f32_32x32x16_bf16 v[144:159], v[196:199], v[140:143], v[144:159]
	ds_read_b64_tr_b16 a[18:19], v220 offset:62464
	ds_read_b64_tr_b16 a[20:21], v221 offset:61440
	ds_read_b64_tr_b16 a[22:23], v221 offset:62464
	v_mfma_f32_32x32x16_bf16 v[144:159], v[204:207], v[208:211], v[144:159]
	ds_read_b64_tr_b16 a[24:25], v220 offset:63488
	ds_read_b64_tr_b16 a[26:27], v220 offset:64512
	ds_read_b64_tr_b16 a[28:29], v221 offset:63488
	s_waitcnt lgkmcnt(13)
	v_mfma_f32_32x32x16_bf16 v[160:175], a[0:3], v[128:131], v[160:175]
	ds_read_b64_tr_b16 a[30:31], v221 offset:64512
	s_waitcnt lgkmcnt(12)
	v_mfma_f32_32x32x16_bf16 v[176:191], v[128:131], a[4:7], v[176:191]
	s_waitcnt lgkmcnt(10)
	v_mfma_f32_32x32x16_bf16 v[160:175], a[8:11], v[132:135], v[160:175]
	s_nop 1
	v_cvt_pk_bf16_f32 v136, v144, v145
	v_cvt_pk_bf16_f32 v137, v146, v147
	v_cvt_pk_bf16_f32 v138, v148, v149
	v_cvt_pk_bf16_f32 v139, v150, v151
	s_waitcnt lgkmcnt(8)
	v_mfma_f32_32x32x16_bf16 v[176:191], v[132:135], a[12:15], v[176:191]
	v_cvt_pk_bf16_f32 v140, v152, v153
	v_cvt_pk_bf16_f32 v141, v154, v155
	v_cvt_pk_bf16_f32 v142, v156, v157
	v_cvt_pk_bf16_f32 v143, v158, v159
	s_waitcnt lgkmcnt(6)
	v_mfma_f32_32x32x16_bf16 v[160:175], a[16:19], v[136:139], v[160:175]
	s_waitcnt lgkmcnt(4)
	v_mfma_f32_32x32x16_bf16 v[176:191], v[136:139], a[20:23], v[176:191]
	s_waitcnt lgkmcnt(2)
	v_mfma_f32_32x32x16_bf16 v[160:175], a[24:27], v[140:143], v[160:175]
	s_waitcnt lgkmcnt(0)
	v_mfma_f32_32x32x16_bf16 v[176:191], v[140:143], a[28:31], v[176:191]
	s_barrier
	s_nop 8
	v_mul_f32 v160, v223, v160
	v_mul_f32 v161, v223, v161
	v_mul_f32 v162, v223, v162
	v_mul_f32 v163, v223, v163
	v_mul_f32 v164, v223, v164
	v_mul_f32 v165, v223, v165
	v_mul_f32 v166, v223, v166
	v_mul_f32 v167, v223, v167
	v_mul_f32 v168, v223, v168
	v_mul_f32 v169, v223, v169
	v_mul_f32 v170, v223, v170
	v_mul_f32 v171, v223, v171
	v_mul_f32 v172, v223, v172
	v_mul_f32 v173, v223, v173
	v_mul_f32 v174, v223, v174
	v_mul_f32 v175, v223, v175
	v_cvt_pk_bf16_f32 v144, v160, v161
	v_cvt_pk_bf16_f32 v145, v162, v163
	v_cvt_pk_bf16_f32 v146, v164, v165
	v_cvt_pk_bf16_f32 v147, v166, v167
	v_cvt_pk_bf16_f32 v148, v168, v169
	v_cvt_pk_bf16_f32 v149, v170, v171
	v_cvt_pk_bf16_f32 v150, v172, v173
	v_cvt_pk_bf16_f32 v151, v174, v175
	v_mfma_f32_32x32x16_bf16 v[160:175], a[224:227], v[144:147], 0
	s_nop 0
	v_mfma_f32_32x32x16_bf16 v[160:175], a[228:231], v[148:151], v[160:175]
	v_mul_f32 v176, v224, v176
	v_mul_f32 v177, v225, v177
	v_mul_f32 v178, v226, v178
	v_mul_f32 v179, v227, v179
	v_mul_f32 v180, v228, v180
	v_mul_f32 v181, v229, v181
	v_mul_f32 v182, v230, v182
	v_mul_f32 v183, v231, v183
	v_mul_f32 v184, v232, v184
	v_mul_f32 v185, v233, v185
	v_mul_f32 v186, v234, v186
	v_mul_f32 v187, v235, v187
	v_mul_f32 v188, v236, v188
	v_mul_f32 v189, v237, v189
	v_mul_f32 v190, v238, v190
	v_mul_f32 v191, v239, v191
	v_cvt_pk_bf16_f32 v152, v176, v177
	v_cvt_pk_bf16_f32 v153, v178, v179
	v_cvt_pk_bf16_f32 v154, v180, v181
	v_cvt_pk_bf16_f32 v155, v182, v183
	v_cvt_pk_bf16_f32 v156, v184, v185
	v_cvt_pk_bf16_f32 v157, v186, v187
	v_cvt_pk_bf16_f32 v158, v188, v189
	v_cvt_pk_bf16_f32 v159, v190, v191
	v_max3_f32 v208, v160, v161, v162
	v_min3_f32 v210, v160, v161, v162
	v_max3_f32 v208, v208, v163, v164
	v_min3_f32 v210, v210, v163, v164
	v_max3_f32 v208, v208, v165, v166
	v_min3_f32 v210, v210, v165, v166
	v_max3_f32 v208, v208, v167, v168
	v_min3_f32 v210, v210, v167, v168
	v_max3_f32 v208, v208, v169, v170
	v_min3_f32 v210, v210, v169, v170
	v_max3_f32 v208, v208, v171, v172
	v_min3_f32 v210, v210, v171, v172
	v_max3_f32 v208, v208, v173, v174
	v_min3_f32 v210, v210, v173, v174
	v_max_f32 v208, v208, v175
	v_min_f32 v210, v210, v175
	v_mul_f32 v208, s62, v208
	v_mul_f32 v210, s62, v210
	v_pk_fma_f32 v[192:193], v[160:161], s[62:63], v[208:209] op_sel_hi:[1,1,0] neg_lo:[0,0,1] neg_hi:[0,0,1]
	v_pk_fma_f32 v[194:195], v[162:163], s[62:63], v[208:209] op_sel_hi:[1,1,0] neg_lo:[0,0,1] neg_hi:[0,0,1]
	v_pk_fma_f32 v[196:197], v[164:165], s[62:63], v[208:209] op_sel_hi:[1,1,0] neg_lo:[0,0,1] neg_hi:[0,0,1]
	v_pk_fma_f32 v[198:199], v[166:167], s[62:63], v[208:209] op_sel_hi:[1,1,0] neg_lo:[0,0,1] neg_hi:[0,0,1]
	v_pk_fma_f32 v[200:201], v[168:169], s[62:63], v[208:209] op_sel_hi:[1,1,0] neg_lo:[0,0,1] neg_hi:[0,0,1]
	v_pk_fma_f32 v[202:203], v[170:171], s[62:63], v[208:209] op_sel_hi:[1,1,0] neg_lo:[0,0,1] neg_hi:[0,0,1]
	v_pk_fma_f32 v[204:205], v[172:173], s[62:63], v[208:209] op_sel_hi:[1,1,0] neg_lo:[0,0,1] neg_hi:[0,0,1]
	v_pk_fma_f32 v[206:207], v[174:175], s[62:63], v[208:209] op_sel_hi:[1,1,0] neg_lo:[0,0,1] neg_hi:[0,0,1]
	v_exp_f32 v192, v192
	v_exp_f32 v193, v193
	v_exp_f32 v194, v194
	v_exp_f32 v195, v195
	v_exp_f32 v196, v196
	v_exp_f32 v197, v197
	v_exp_f32 v198, v198
	v_exp_f32 v199, v199
	v_exp_f32 v200, v200
	v_exp_f32 v201, v201
	v_exp_f32 v202, v202
	v_exp_f32 v203, v203
	v_exp_f32 v204, v204
	v_exp_f32 v205, v205
	v_exp_f32 v206, v206
	v_exp_f32 v207, v207
	v_pk_add_f32 v[212:213], v[192:193], v[194:195]
	v_pk_add_f32 v[212:213], v[212:213], v[196:197]
	v_pk_add_f32 v[212:213], v[212:213], v[198:199]
	v_pk_add_f32 v[212:213], v[212:213], v[200:201]
	v_pk_add_f32 v[212:213], v[212:213], v[202:203]
	v_pk_add_f32 v[212:213], v[212:213], v[204:205]
	v_pk_add_f32 v[212:213], v[212:213], v[206:207]
	v_add_f32 v212, v212, v213
	v_rcp_f32 v212, v212
	s_nop 0
	v_pk_mul_f32 v[192:193], v[192:193], v[212:213] op_sel_hi:[1,0]
	v_pk_mul_f32 v[194:195], v[194:195], v[212:213] op_sel_hi:[1,0]
	v_pk_mul_f32 v[196:197], v[196:197], v[212:213] op_sel_hi:[1,0]
	v_pk_mul_f32 v[198:199], v[198:199], v[212:213] op_sel_hi:[1,0]
	v_pk_mul_f32 v[200:201], v[200:201], v[212:213] op_sel_hi:[1,0]
	v_pk_mul_f32 v[202:203], v[202:203], v[212:213] op_sel_hi:[1,0]
	v_pk_mul_f32 v[204:205], v[204:205], v[212:213] op_sel_hi:[1,0]
	v_pk_mul_f32 v[206:207], v[206:207], v[212:213] op_sel_hi:[1,0]
	v_cvt_pk_bf16_f32 v224, v192, v193
	v_cvt_pk_bf16_f32 v225, v194, v195
	v_cvt_pk_bf16_f32 v226, v196, v197
	v_cvt_pk_bf16_f32 v227, v198, v199
	v_cvt_pk_bf16_f32 v228, v200, v201
	v_cvt_pk_bf16_f32 v229, v202, v203
	v_cvt_pk_bf16_f32 v230, v204, v205
	v_cvt_pk_bf16_f32 v231, v206, v207
	v_pk_fma_f32 v[192:193], v[160:161], s[62:63], v[210:211] op_sel_hi:[1,1,0] neg_lo:[1,0,0] neg_hi:[1,0,0]
	v_pk_fma_f32 v[194:195], v[162:163], s[62:63], v[210:211] op_sel_hi:[1,1,0] neg_lo:[1,0,0] neg_hi:[1,0,0]
	v_pk_fma_f32 v[196:197], v[164:165], s[62:63], v[210:211] op_sel_hi:[1,1,0] neg_lo:[1,0,0] neg_hi:[1,0,0]
	v_pk_fma_f32 v[198:199], v[166:167], s[62:63], v[210:211] op_sel_hi:[1,1,0] neg_lo:[1,0,0] neg_hi:[1,0,0]
	v_pk_fma_f32 v[200:201], v[168:169], s[62:63], v[210:211] op_sel_hi:[1,1,0] neg_lo:[1,0,0] neg_hi:[1,0,0]
	v_pk_fma_f32 v[202:203], v[170:171], s[62:63], v[210:211] op_sel_hi:[1,1,0] neg_lo:[1,0,0] neg_hi:[1,0,0]
	v_pk_fma_f32 v[204:205], v[172:173], s[62:63], v[210:211] op_sel_hi:[1,1,0] neg_lo:[1,0,0] neg_hi:[1,0,0]
	v_pk_fma_f32 v[206:207], v[174:175], s[62:63], v[210:211] op_sel_hi:[1,1,0] neg_lo:[1,0,0] neg_hi:[1,0,0]
	v_exp_f32 v192, v192
	v_exp_f32 v193, v193
	v_exp_f32 v194, v194
	v_exp_f32 v195, v195
	v_exp_f32 v196, v196
	v_exp_f32 v197, v197
	v_exp_f32 v198, v198
	v_exp_f32 v199, v199
	v_exp_f32 v200, v200
	v_exp_f32 v201, v201
	v_exp_f32 v202, v202
	v_exp_f32 v203, v203
	v_exp_f32 v204, v204
	v_exp_f32 v205, v205
	v_exp_f32 v206, v206
	v_exp_f32 v207, v207
	v_pk_add_f32 v[212:213], v[192:193], v[194:195]
	v_pk_add_f32 v[212:213], v[212:213], v[196:197]
	v_pk_add_f32 v[212:213], v[212:213], v[198:199]
	v_pk_add_f32 v[212:213], v[212:213], v[200:201]
	v_pk_add_f32 v[212:213], v[212:213], v[202:203]
	v_pk_add_f32 v[212:213], v[212:213], v[204:205]
	v_pk_add_f32 v[212:213], v[212:213], v[206:207]
	v_add_f32 v212, v212, v213
	v_rcp_f32 v212, v212
	s_nop 0
	v_pk_mul_f32 v[192:193], v[192:193], v[212:213] op_sel_hi:[1,0]
	v_pk_mul_f32 v[194:195], v[194:195], v[212:213] op_sel_hi:[1,0]
	v_pk_mul_f32 v[196:197], v[196:197], v[212:213] op_sel_hi:[1,0]
	v_pk_mul_f32 v[198:199], v[198:199], v[212:213] op_sel_hi:[1,0]
	v_pk_mul_f32 v[200:201], v[200:201], v[212:213] op_sel_hi:[1,0]
	v_pk_mul_f32 v[202:203], v[202:203], v[212:213] op_sel_hi:[1,0]
	v_pk_mul_f32 v[204:205], v[204:205], v[212:213] op_sel_hi:[1,0]
	v_pk_mul_f32 v[206:207], v[206:207], v[212:213] op_sel_hi:[1,0]
	v_cvt_pk_bf16_f32 v232, v192, v193
	v_cvt_pk_bf16_f32 v233, v194, v195
	v_cvt_pk_bf16_f32 v234, v196, v197
	v_cvt_pk_bf16_f32 v235, v198, v199
	v_cvt_pk_bf16_f32 v236, v200, v201
	v_cvt_pk_bf16_f32 v237, v202, v203
	v_cvt_pk_bf16_f32 v238, v204, v205
	v_cvt_pk_bf16_f32 v239, v206, v207
	v_mfma_f32_32x32x16_bf16 v[176:191], v[224:227], a[232:235], 0
	v_mfma_f32_32x32x16_bf16 v[160:175], v[232:235], a[240:243], 0
	v_mfma_f32_32x32x16_bf16 v[176:191], v[228:231], a[236:239], v[176:191]
	v_mfma_f32_32x32x16_bf16 v[160:175], v[236:239], a[244:247], v[160:175]
	s_nop 10
	v_cvt_pk_bf16_f32 v224, v176, v177
	v_cvt_pk_bf16_f32 v225, v178, v179
	v_cvt_pk_bf16_f32 v226, v180, v181
	v_cvt_pk_bf16_f32 v227, v182, v183
	v_cvt_pk_bf16_f32 v228, v184, v185
	v_cvt_pk_bf16_f32 v229, v186, v187
	v_cvt_pk_bf16_f32 v230, v188, v189
	v_cvt_pk_bf16_f32 v231, v190, v191
	v_mfma_f32_32x32x16_bf16 v[192:207], v[224:227], v[152:155], 0
	s_nop 0
	v_mfma_f32_32x32x16_bf16 v[192:207], v[228:231], v[156:159], v[192:207]
	v_cvt_pk_bf16_f32 v232, v160, v161
	v_cvt_pk_bf16_f32 v233, v162, v163
	v_cvt_pk_bf16_f32 v234, v164, v165
	v_cvt_pk_bf16_f32 v235, v166, v167
	v_cvt_pk_bf16_f32 v236, v168, v169
	v_cvt_pk_bf16_f32 v237, v170, v171
	v_cvt_pk_bf16_f32 v238, v172, v173
	v_cvt_pk_bf16_f32 v239, v174, v175
	v_mfma_f32_32x32x16_bf16 v[240:255], v[232:235], v[152:155], 0
	s_nop 0
	v_mfma_f32_32x32x16_bf16 v[240:255], v[236:239], v[156:159], v[240:255]
	v_add_f32 v208, v176, v177
	v_add_f32 v209, v178, v179
	v_add_f32 v208, v208, v180
	v_add_f32 v209, v209, v181
	v_add_f32 v208, v208, v182
	v_add_f32 v209, v209, v183
	v_add_f32 v208, v208, v184
	v_add_f32 v209, v209, v185
	v_add_f32 v208, v208, v186
	v_add_f32 v209, v209, v187
	v_add_f32 v208, v208, v188
	v_add_f32 v209, v209, v189
	v_add_f32 v208, v208, v190
	v_add_f32 v209, v209, v191
	v_add_f32 v210, v160, v161
	v_add_f32 v211, v162, v163
	v_add_f32 v210, v210, v164
	v_add_f32 v211, v211, v165
	v_add_f32 v210, v210, v166
	v_add_f32 v211, v211, v167
	v_add_f32 v210, v210, v168
	v_add_f32 v211, v211, v169
	v_add_f32 v210, v210, v170
	v_add_f32 v211, v211, v171
	v_add_f32 v210, v210, v172
	v_add_f32 v211, v211, v173
	v_add_f32 v210, v210, v174
	v_add_f32 v211, v211, v175
	v_add_f32 v212, v208, v209
	v_add_f32 v213, v210, v211
	v_cndmask_b32 v192, v240, v192, s[66:67]
	v_cndmask_b32 v193, v241, v193, s[66:67]
	v_cndmask_b32 v194, v242, v194, s[66:67]
	v_cndmask_b32 v195, v243, v195, s[66:67]
	v_cndmask_b32 v196, v244, v196, s[66:67]
	v_cndmask_b32 v197, v245, v197, s[66:67]
	v_cndmask_b32 v198, v246, v198, s[66:67]
	v_cndmask_b32 v199, v247, v199, s[66:67]
	v_cndmask_b32 v200, v248, v200, s[66:67]
	v_cndmask_b32 v201, v249, v201, s[66:67]
	v_cndmask_b32 v202, v250, v202, s[66:67]
	v_cndmask_b32 v203, v251, v203, s[66:67]
	v_cndmask_b32 v204, v252, v204, s[66:67]
	v_cndmask_b32 v205, v253, v205, s[66:67]
	v_cndmask_b32 v206, v254, v206, s[66:67]
	v_cndmask_b32 v207, v255, v207, s[66:67]
	s_mul_i32 s55, s52, 4608
	s_add_u32 s55, s55, 0
	v_add_u32 v8, s55, v2
	ds_write_b128 v8, v[192:195] offset:0
	ds_write_b128 v8, v[196:199] offset:1024
	ds_write_b128 v8, v[200:203] offset:2048
	ds_write_b128 v8, v[204:207] offset:3072
	v_lshlrev_b32 v9, 3, v1
	v_add_u32 v9, s55, v9
	ds_write_b64 v9, v[212:213] offset:4096
	s_waitcnt lgkmcnt(0)
	s_barrier
	s_lshl_b32 s55, s52, 10
	s_add_u32 s55, s55, 0
	v_add_u32 v8, s55, v2
	ds_read_b128 v[192:195], v8 offset:0
	ds_read_b128 v[196:199], v8 offset:4608
	ds_read_b128 v[200:203], v8 offset:9216
	ds_read_b128 v[204:207], v8 offset:13824
	v_lshlrev_b32 v9, 3, v1
	v_add_u32 v9, 4096, v9
	ds_read_b64 v[240:241], v9 offset:0
	ds_read_b64 v[242:243], v9 offset:4608
	ds_read_b64 v[244:245], v9 offset:9216
	ds_read_b64 v[246:247], v9 offset:13824
	s_waitcnt lgkmcnt(0)
	v_pk_add_f32 v[192:193], v[192:193], v[196:197]
	v_pk_add_f32 v[200:201], v[200:201], v[204:205]
	v_pk_add_f32 v[192:193], v[192:193], v[200:201]
	v_pk_add_f32 v[194:195], v[194:195], v[198:199]
	v_pk_add_f32 v[202:203], v[202:203], v[206:207]
	v_pk_add_f32 v[194:195], v[194:195], v[202:203]
	v_cvt_pk_bf16_f32 v192, v192, v193
	v_cvt_pk_bf16_f32 v193, v194, v195
	v_pk_add_f32 v[240:241], v[240:241], v[242:243]
	v_pk_add_f32 v[244:245], v[244:245], v[246:247]
	v_pk_add_f32 v[240:241], v[240:241], v[244:245]
	v_cvt_pk_bf16_f32 v240, v240, v241
	v_mov_b32 v194, v240
	v_mov_b32 v195, v3
	s_lshl_b32 s55, s51, 4
	s_add_u32 s55, s55, s50
	s_lshl_b32 s56, s55, 12
	s_lshl_b32 s57, s52, 10
	s_add_u32 s56, s56, s57
	s_add_u32 s56, s56, 1048576
	buffer_store_dwordx4 v[192:195], v2, s[44:47], s56 offen sc1
	s_waitcnt vmcnt(5)
	s_barrier
	s_sub_u32 s55, s2, 64
	s_cmp_ge_u32 s55, 128
	s_cbranch_scc1 L_mn_i_9
	v_lshrrev_b32 v7, 1, v1
	v_mul_u32_u24 v7, 6144, v7
	v_and_b32 v8, 1, v1
	v_lshlrev_b32 v8, 4, v8
	s_lshl_b32 s55, s100, 5
	v_add3_u32 v7, v7, v8, s55
	s_mul_i32 s65, s52, 786432
	s_lshl_b32 s55, s52, 12
	s_add_u32 m0, s55, 114688
	s_nop 0
	buffer_load_dwordx4 v7, s[36:39], s65 offen lds
	s_add_u32 m0, m0, 1024
	s_add_u32 s65, s65, 196608
	buffer_load_dwordx4 v7, s[36:39], s65 offen lds
	s_add_u32 m0, m0, 1024
	s_add_u32 s65, s65, 196608
	buffer_load_dwordx4 v7, s[36:39], s65 offen lds
	s_add_u32 m0, m0, 1024
	s_add_u32 s65, s65, 196608
	buffer_load_dwordx4 v7, s[36:39], s65 offen lds
L_mn_i_9:
	ds_read_b64_tr_b16 a[0:1], v4 offset:0
	ds_read_b64_tr_b16 a[2:3], v4 offset:512
	ds_read_b64_tr_b16 a[4:5], v4 offset:1024
	ds_read_b64_tr_b16 a[6:7], v4 offset:1536
	ds_read_b64_tr_b16 a[8:9], v4 offset:2048
	ds_read_b64_tr_b16 a[10:11], v4 offset:2560
	ds_read_b64_tr_b16 a[12:13], v4 offset:3072
	ds_read_b64_tr_b16 a[14:15], v4 offset:3584
	ds_read_b64_tr_b16 a[16:17], v4 offset:4096
	ds_read_b64_tr_b16 a[18:19], v4 offset:4608
	s_waitcnt lgkmcnt(8)
	v_mfma_f32_32x32x16_bf16 v[144:159], a[0:3], v[16:19], 0
	ds_read_b64_tr_b16 a[20:21], v4 offset:5120
	ds_read_b64_tr_b16 a[22:23], v4 offset:5632
	s_waitcnt lgkmcnt(8)
	v_mfma_f32_32x32x16_bf16 v[144:159], a[4:7], v[20:23], v[144:159]
	ds_read_b64_tr_b16 a[0:1], v4 offset:6144
	ds_read_b64_tr_b16 a[2:3], v4 offset:6656
	s_waitcnt lgkmcnt(8)
	v_mfma_f32_32x32x16_bf16 v[144:159], a[8:11], v[24:27], v[144:159]
	ds_read_b64_tr_b16 a[4:5], v4 offset:7168
	ds_read_b64_tr_b16 a[6:7], v4 offset:7680
	s_waitcnt lgkmcnt(8)
	v_mfma_f32_32x32x16_bf16 v[144:159], a[12:15], v[28:31], v[144:159]
	ds_read_b64_tr_b16 a[8:9], v4 offset:8192
	ds_read_b64_tr_b16 a[10:11], v4 offset:8704
	s_waitcnt lgkmcnt(8)
	v_mfma_f32_32x32x16_bf16 v[144:159], a[16:19], v[32:35], v[144:159]
	ds_read_b64_tr_b16 a[12:13], v4 offset:9216
	ds_read_b64_tr_b16 a[14:15], v4 offset:9728
	s_waitcnt lgkmcnt(8)
	v_mfma_f32_32x32x16_bf16 v[144:159], a[20:23], v[36:39], v[144:159]
	ds_read_b64_tr_b16 a[16:17], v4 offset:10240
	ds_read_b64_tr_b16 a[18:19], v4 offset:10752
	s_waitcnt lgkmcnt(8)
	v_mfma_f32_32x32x16_bf16 v[144:159], a[0:3], v[40:43], v[144:159]
	ds_read_b64_tr_b16 a[20:21], v4 offset:11264
	ds_read_b64_tr_b16 a[22:23], v4 offset:11776
	s_waitcnt lgkmcnt(8)
	v_mfma_f32_32x32x16_bf16 v[144:159], a[4:7], v[44:47], v[144:159]
	ds_read_b64_tr_b16 a[0:1], v4 offset:12288
	ds_read_b64_tr_b16 a[2:3], v4 offset:12800
	s_waitcnt lgkmcnt(8)
	v_mfma_f32_32x32x16_bf16 v[144:159], a[8:11], v[48:51], v[144:159]
	ds_read_b64_tr_b16 a[4:5], v4 offset:13312
	ds_read_b64_tr_b16 a[6:7], v4 offset:13824
	s_waitcnt lgkmcnt(8)
	v_mfma_f32_32x32x16_bf16 v[144:159], a[12:15], v[52:55], v[144:159]
	ds_read_b64_tr_b16 a[8:9], v4 offset:14336
	ds_read_b64_tr_b16 a[10:11], v4 offset:14848
	s_waitcnt lgkmcnt(8)
	v_mfma_f32_32x32x16_bf16 v[144:159], a[16:19], v[56:59], v[144:159]
	ds_read_b64_tr_b16 a[12:13], v4 offset:15360
	ds_read_b64_tr_b16 a[14:15], v4 offset:15872
	s_waitcnt lgkmcnt(8)
	v_mfma_f32_32x32x16_bf16 v[144:159], a[20:23], v[60:63], v[144:159]
	ds_read_b64_tr_b16 a[16:17], v4 offset:16384
	ds_read_b64_tr_b16 a[18:19], v4 offset:16896
	s_waitcnt lgkmcnt(8)
	v_mfma_f32_32x32x16_bf16 v[144:159], a[0:3], v[64:67], v[144:159]
	ds_read_b64_tr_b16 a[20:21], v4 offset:17408
	ds_read_b64_tr_b16 a[22:23], v4 offset:17920
	s_waitcnt lgkmcnt(8)
	v_mfma_f32_32x32x16_bf16 v[144:159], a[4:7], v[68:71], v[144:159]
	ds_read_b64_tr_b16 a[0:1], v4 offset:18432
	ds_read_b64_tr_b16 a[2:3], v4 offset:18944
	s_waitcnt lgkmcnt(8)
	v_mfma_f32_32x32x16_bf16 v[144:159], a[8:11], v[72:75], v[144:159]
	ds_read_b64_tr_b16 a[4:5], v4 offset:19456
	ds_read_b64_tr_b16 a[6:7], v4 offset:19968
	s_waitcnt lgkmcnt(8)
	v_mfma_f32_32x32x16_bf16 v[144:159], a[12:15], v[76:79], v[144:159]
	ds_read_b64_tr_b16 a[8:9], v4 offset:20480
	ds_read_b64_tr_b16 a[10:11], v4 offset:20992
	s_waitcnt lgkmcnt(8)
	v_mfma_f32_32x32x16_bf16 v[144:159], a[16:19], v[80:83], v[144:159]
	ds_read_b64_tr_b16 a[12:13], v4 offset:21504
	ds_read_b64_tr_b16 a[14:15], v4 offset:22016
	s_waitcnt lgkmcnt(8)
	v_mfma_f32_32x32x16_bf16 v[144:159], a[20:23], v[84:87], v[144:159]
	ds_read_b64_tr_b16 a[16:17], v4 offset:22528
	ds_read_b64_tr_b16 a[18:19], v4 offset:23040
	s_waitcnt lgkmcnt(8)
	v_mfma_f32_32x32x16_bf16 v[144:159], a[0:3], v[88:91], v[144:159]
	ds_read_b64_tr_b16 a[20:21], v4 offset:23552
	ds_read_b64_tr_b16 a[22:23], v4 offset:24064
	s_waitcnt lgkmcnt(8)
	v_mfma_f32_32x32x16_bf16 v[144:159], a[4:7], v[92:95], v[144:159]
	ds_read_b64_tr_b16 a[0:1], v4 offset:24576
	ds_read_b64_tr_b16 a[2:3], v4 offset:25088
	s_waitcnt lgkmcnt(8)
	v_mfma_f32_32x32x16_bf16 v[144:159], a[8:11], v[96:99], v[144:159]
	ds_read_b64_tr_b16 a[4:5], v4 offset:25600
	ds_read_b64_tr_b16 a[6:7], v4 offset:26112
	s_waitcnt lgkmcnt(8)
	v_mfma_f32_32x32x16_bf16 v[144:159], a[12:15], v[100:103], v[144:159]
	ds_read_b64_tr_b16 a[8:9], v4 offset:26624
	ds_read_b64_tr_b16 a[10:11], v4 offset:27136
	s_waitcnt lgkmcnt(8)
	v_mfma_f32_32x32x16_bf16 v[144:159], a[16:19], v[104:107], v[144:159]
	ds_read_b64_tr_b16 a[12:13], v4 offset:27648
	ds_read_b64_tr_b16 a[14:15], v4 offset:28160
	s_waitcnt lgkmcnt(8)
	v_mfma_f32_32x32x16_bf16 v[144:159], a[20:23], v[108:111], v[144:159]
	ds_read_b64_tr_b16 a[16:17], v4 offset:28672
	ds_read_b64_tr_b16 a[18:19], v4 offset:29184
	s_waitcnt lgkmcnt(8)
	v_mfma_f32_32x32x16_bf16 v[144:159], a[0:3], v[112:115], v[144:159]
	ds_read_b64_tr_b16 a[20:21], v4 offset:29696
	ds_read_b64_tr_b16 a[22:23], v4 offset:30208
	s_waitcnt lgkmcnt(8)
	v_mfma_f32_32x32x16_bf16 v[144:159], a[4:7], v[116:119], v[144:159]
	ds_read_b64_tr_b16 a[0:1], v4 offset:30720
	ds_read_b64_tr_b16 a[2:3], v4 offset:31232
	s_waitcnt lgkmcnt(8)
	v_mfma_f32_32x32x16_bf16 v[144:159], a[8:11], v[120:123], v[144:159]
	ds_read_b64_tr_b16 a[4:5], v4 offset:31744
	ds_read_b64_tr_b16 a[6:7], v4 offset:32256
	s_waitcnt lgkmcnt(8)
	v_mfma_f32_32x32x16_bf16 v[144:159], a[12:15], v[124:127], v[144:159]
	s_waitcnt lgkmcnt(6)
	v_mfma_f32_32x32x16_bf16 v[144:159], a[16:19], v[128:131], v[144:159]
	s_waitcnt lgkmcnt(4)
	v_mfma_f32_32x32x16_bf16 v[144:159], a[20:23], v[132:135], v[144:159]
	s_waitcnt lgkmcnt(2)
	v_mfma_f32_32x32x16_bf16 v[144:159], a[0:3], v[136:139], v[144:159]
	s_waitcnt lgkmcnt(0)
	v_mfma_f32_32x32x16_bf16 v[144:159], a[4:7], v[140:143], v[144:159]
	s_lshl_b32 s35, s51, 16
	s_lshl_b32 s57, s52, 10
	s_add_u32 s35, s35, s57
	s_add_u32 s35, s35, 1048576
	s_mov_b32 s65, s35
	buffer_load_dwordx4 v[16:19], v2, s[44:47], s65 offen sc1
	s_add_u32 s65, s65, 4096
	buffer_load_dwordx4 v[20:23], v2, s[44:47], s65 offen sc1
	s_add_u32 s65, s65, 4096
	buffer_load_dwordx4 v[24:27], v2, s[44:47], s65 offen sc1
	s_add_u32 s65, s65, 4096
	buffer_load_dwordx4 v[28:31], v2, s[44:47], s65 offen sc1
	s_add_u32 s65, s65, 4096
	buffer_load_dwordx4 v[32:35], v2, s[44:47], s65 offen sc1
	s_add_u32 s65, s65, 4096
	buffer_load_dwordx4 v[36:39], v2, s[44:47], s65 offen sc1
	s_add_u32 s65, s65, 4096
	buffer_load_dwordx4 v[40:43], v2, s[44:47], s65 offen sc1
	s_add_u32 s65, s65, 4096
	buffer_load_dwordx4 v[44:47], v2, s[44:47], s65 offen sc1
	s_add_u32 s65, s65, 4096
	buffer_load_dwordx4 v[48:51], v2, s[44:47], s65 offen sc1
	s_add_u32 s65, s65, 4096
	buffer_load_dwordx4 v[52:55], v2, s[44:47], s65 offen sc1
	s_add_u32 s65, s65, 4096
	buffer_load_dwordx4 v[56:59], v2, s[44:47], s65 offen sc1
	s_add_u32 s65, s65, 4096
	buffer_load_dwordx4 v[60:63], v2, s[44:47], s65 offen sc1
	s_add_u32 s65, s65, 4096
	buffer_load_dwordx4 v[64:67], v2, s[44:47], s65 offen sc1
	s_add_u32 s65, s65, 4096
	buffer_load_dwordx4 v[68:71], v2, s[44:47], s65 offen sc1
	s_add_u32 s65, s65, 4096
	buffer_load_dwordx4 v[72:75], v2, s[44:47], s65 offen sc1
	s_add_u32 s65, s65, 4096
	buffer_load_dwordx4 v[76:79], v2, s[44:47], s65 offen sc1
	v_mul_f32 v144, v223, v144
	v_mul_f32 v145, v223, v145
	v_mul_f32 v146, v223, v146
	v_mul_f32 v147, v223, v147
	v_mul_f32 v148, v223, v148
	v_mul_f32 v149, v223, v149
	v_mul_f32 v150, v223, v150
	v_mul_f32 v151, v223, v151
	v_mul_f32 v152, v223, v152
	v_mul_f32 v153, v223, v153
	v_mul_f32 v154, v223, v154
	v_mul_f32 v155, v223, v155
	v_mul_f32 v156, v223, v156
	v_mul_f32 v157, v223, v157
	v_mul_f32 v158, v223, v158
	v_mul_f32 v159, v223, v159
	v_cvt_pk_bf16_f32 v160, v144, v145
	v_cvt_pk_bf16_f32 v161, v146, v147
	v_cvt_pk_bf16_f32 v162, v148, v149
	v_cvt_pk_bf16_f32 v163, v150, v151
	v_cvt_pk_bf16_f32 v164, v152, v153
	v_cvt_pk_bf16_f32 v165, v154, v155
	v_cvt_pk_bf16_f32 v166, v156, v157
	v_cvt_pk_bf16_f32 v167, v158, v159
	v_mfma_f32_32x32x16_bf16 v[176:191], a[224:227], v[160:163], 0
	s_nop 0
	v_mfma_f32_32x32x16_bf16 v[176:191], a[228:231], v[164:167], v[176:191]
	s_and_b32 s96, s52, 1
	s_lshr_b32 s97, s52, 1
	s_lshr_b32 s55, s71, 3
	s_lshl_b32 s55, s55, 1
	s_lshl_b32 s98, s70, 2
	s_add_u32 s98, s98, s55
	s_add_u32 s98, s98, s96
	s_and_b32 s99, s71, 7
	s_lshl_b32 s99, s99, 1
	s_add_u32 s99, s99, s97
	s_nop 1
	v_max3_f32 v208, v176, v177, v178
	v_min3_f32 v210, v176, v177, v178
	v_max3_f32 v208, v208, v179, v180
	v_min3_f32 v210, v210, v179, v180
	v_max3_f32 v208, v208, v181, v182
	v_min3_f32 v210, v210, v181, v182
	v_max3_f32 v208, v208, v183, v184
	v_min3_f32 v210, v210, v183, v184
	v_max3_f32 v208, v208, v185, v186
	v_min3_f32 v210, v210, v185, v186
	v_max3_f32 v208, v208, v187, v188
	v_min3_f32 v210, v210, v187, v188
	v_max3_f32 v208, v208, v189, v190
	v_min3_f32 v210, v210, v189, v190
	v_max_f32 v208, v208, v191
	v_min_f32 v210, v210, v191
	v_mul_f32 v208, s62, v208
	v_mul_f32 v210, s62, v210
	v_pk_fma_f32 v[192:193], v[176:177], s[62:63], v[208:209] op_sel_hi:[1,1,0] neg_lo:[0,0,1] neg_hi:[0,0,1]
	v_pk_fma_f32 v[194:195], v[178:179], s[62:63], v[208:209] op_sel_hi:[1,1,0] neg_lo:[0,0,1] neg_hi:[0,0,1]
	v_pk_fma_f32 v[196:197], v[180:181], s[62:63], v[208:209] op_sel_hi:[1,1,0] neg_lo:[0,0,1] neg_hi:[0,0,1]
	v_pk_fma_f32 v[198:199], v[182:183], s[62:63], v[208:209] op_sel_hi:[1,1,0] neg_lo:[0,0,1] neg_hi:[0,0,1]
	v_pk_fma_f32 v[200:201], v[184:185], s[62:63], v[208:209] op_sel_hi:[1,1,0] neg_lo:[0,0,1] neg_hi:[0,0,1]
	v_pk_fma_f32 v[202:203], v[186:187], s[62:63], v[208:209] op_sel_hi:[1,1,0] neg_lo:[0,0,1] neg_hi:[0,0,1]
	v_pk_fma_f32 v[204:205], v[188:189], s[62:63], v[208:209] op_sel_hi:[1,1,0] neg_lo:[0,0,1] neg_hi:[0,0,1]
	v_pk_fma_f32 v[206:207], v[190:191], s[62:63], v[208:209] op_sel_hi:[1,1,0] neg_lo:[0,0,1] neg_hi:[0,0,1]
	v_exp_f32 v192, v192
	v_exp_f32 v193, v193
	v_exp_f32 v194, v194
	v_exp_f32 v195, v195
	v_exp_f32 v196, v196
	v_exp_f32 v197, v197
	v_exp_f32 v198, v198
	v_exp_f32 v199, v199
	v_exp_f32 v200, v200
	v_exp_f32 v201, v201
	v_exp_f32 v202, v202
	v_exp_f32 v203, v203
	v_exp_f32 v204, v204
	v_exp_f32 v205, v205
	v_exp_f32 v206, v206
	v_exp_f32 v207, v207
	v_pk_add_f32 v[212:213], v[192:193], v[194:195]
	v_pk_add_f32 v[212:213], v[212:213], v[196:197]
	v_pk_add_f32 v[212:213], v[212:213], v[198:199]
	v_pk_add_f32 v[212:213], v[212:213], v[200:201]
	v_pk_add_f32 v[212:213], v[212:213], v[202:203]
	v_pk_add_f32 v[212:213], v[212:213], v[204:205]
	v_pk_add_f32 v[212:213], v[212:213], v[206:207]
	v_add_f32 v212, v212, v213
	v_rcp_f32 v212, v212
	s_nop 0
	v_pk_mul_f32 v[192:193], v[192:193], v[212:213] op_sel_hi:[1,0]
	v_pk_mul_f32 v[194:195], v[194:195], v[212:213] op_sel_hi:[1,0]
	v_pk_mul_f32 v[196:197], v[196:197], v[212:213] op_sel_hi:[1,0]
	v_pk_mul_f32 v[198:199], v[198:199], v[212:213] op_sel_hi:[1,0]
	v_pk_mul_f32 v[200:201], v[200:201], v[212:213] op_sel_hi:[1,0]
	v_pk_mul_f32 v[202:203], v[202:203], v[212:213] op_sel_hi:[1,0]
	v_pk_mul_f32 v[204:205], v[204:205], v[212:213] op_sel_hi:[1,0]
	v_pk_mul_f32 v[206:207], v[206:207], v[212:213] op_sel_hi:[1,0]
	v_cvt_pk_bf16_f32 v96, v192, v193
	v_cvt_pk_bf16_f32 v97, v194, v195
	v_cvt_pk_bf16_f32 v98, v196, v197
	v_cvt_pk_bf16_f32 v99, v198, v199
	v_cvt_pk_bf16_f32 v100, v200, v201
	v_cvt_pk_bf16_f32 v101, v202, v203
	v_cvt_pk_bf16_f32 v102, v204, v205
	v_cvt_pk_bf16_f32 v103, v206, v207
	v_pk_fma_f32 v[192:193], v[176:177], s[62:63], v[210:211] op_sel_hi:[1,1,0] neg_lo:[1,0,0] neg_hi:[1,0,0]
	v_pk_fma_f32 v[194:195], v[178:179], s[62:63], v[210:211] op_sel_hi:[1,1,0] neg_lo:[1,0,0] neg_hi:[1,0,0]
	v_pk_fma_f32 v[196:197], v[180:181], s[62:63], v[210:211] op_sel_hi:[1,1,0] neg_lo:[1,0,0] neg_hi:[1,0,0]
	v_pk_fma_f32 v[198:199], v[182:183], s[62:63], v[210:211] op_sel_hi:[1,1,0] neg_lo:[1,0,0] neg_hi:[1,0,0]
	v_pk_fma_f32 v[200:201], v[184:185], s[62:63], v[210:211] op_sel_hi:[1,1,0] neg_lo:[1,0,0] neg_hi:[1,0,0]
	v_pk_fma_f32 v[202:203], v[186:187], s[62:63], v[210:211] op_sel_hi:[1,1,0] neg_lo:[1,0,0] neg_hi:[1,0,0]
	v_pk_fma_f32 v[204:205], v[188:189], s[62:63], v[210:211] op_sel_hi:[1,1,0] neg_lo:[1,0,0] neg_hi:[1,0,0]
	v_pk_fma_f32 v[206:207], v[190:191], s[62:63], v[210:211] op_sel_hi:[1,1,0] neg_lo:[1,0,0] neg_hi:[1,0,0]
	v_exp_f32 v192, v192
	v_exp_f32 v193, v193
	v_exp_f32 v194, v194
	v_exp_f32 v195, v195
	v_exp_f32 v196, v196
	v_exp_f32 v197, v197
	v_exp_f32 v198, v198
	v_exp_f32 v199, v199
	v_exp_f32 v200, v200
	v_exp_f32 v201, v201
	v_exp_f32 v202, v202
	v_exp_f32 v203, v203
	v_exp_f32 v204, v204
	v_exp_f32 v205, v205
	v_exp_f32 v206, v206
	v_exp_f32 v207, v207
	v_pk_add_f32 v[212:213], v[192:193], v[194:195]
	v_pk_add_f32 v[212:213], v[212:213], v[196:197]
	v_pk_add_f32 v[212:213], v[212:213], v[198:199]
	v_pk_add_f32 v[212:213], v[212:213], v[200:201]
	v_pk_add_f32 v[212:213], v[212:213], v[202:203]
	v_pk_add_f32 v[212:213], v[212:213], v[204:205]
	v_pk_add_f32 v[212:213], v[212:213], v[206:207]
	v_add_f32 v212, v212, v213
	v_rcp_f32 v212, v212
	s_nop 0
	v_pk_mul_f32 v[192:193], v[192:193], v[212:213] op_sel_hi:[1,0]
	v_pk_mul_f32 v[194:195], v[194:195], v[212:213] op_sel_hi:[1,0]
	v_pk_mul_f32 v[196:197], v[196:197], v[212:213] op_sel_hi:[1,0]
	v_pk_mul_f32 v[198:199], v[198:199], v[212:213] op_sel_hi:[1,0]
	v_pk_mul_f32 v[200:201], v[200:201], v[212:213] op_sel_hi:[1,0]
	v_pk_mul_f32 v[202:203], v[202:203], v[212:213] op_sel_hi:[1,0]
	v_pk_mul_f32 v[204:205], v[204:205], v[212:213] op_sel_hi:[1,0]
	v_pk_mul_f32 v[206:207], v[206:207], v[212:213] op_sel_hi:[1,0]
	v_cvt_pk_bf16_f32 v104, v192, v193
	v_cvt_pk_bf16_f32 v105, v194, v195
	v_cvt_pk_bf16_f32 v106, v196, v197
	v_cvt_pk_bf16_f32 v107, v198, v199
	v_cvt_pk_bf16_f32 v108, v200, v201
	v_cvt_pk_bf16_f32 v109, v202, v203
	v_cvt_pk_bf16_f32 v110, v204, v205
	v_cvt_pk_bf16_f32 v111, v206, v207
	v_mov_b32 v10, 0x3f80
	v_mov_b32 v11, 0x3f800000
	v_mov_b32 v176, 0
	v_mov_b32 v177, 0
	v_mov_b32 v178, 0
	v_mov_b32 v179, 0
	v_mov_b32 v180, 0
	v_mov_b32 v181, 0
	s_waitcnt vmcnt(0)
	v_cmp_ne_u32 vcc, s53, v19
	v_cmp_ne_u32 s[68:69], s53, v23
	s_nop 0
	s_or_b64 vcc, vcc, s[68:69]
	v_cmp_ne_u32 s[68:69], s53, v27
	s_nop 0
	s_or_b64 vcc, vcc, s[68:69]
	v_cmp_ne_u32 s[68:69], s53, v31
	s_nop 0
	s_or_b64 vcc, vcc, s[68:69]
	v_cmp_ne_u32 s[68:69], s53, v35
	s_nop 0
	s_or_b64 vcc, vcc, s[68:69]
	v_cmp_ne_u32 s[68:69], s53, v39
	s_nop 0
	s_or_b64 vcc, vcc, s[68:69]
	v_cmp_ne_u32 s[68:69], s53, v43
	s_nop 0
	s_or_b64 vcc, vcc, s[68:69]
	v_cmp_ne_u32 s[68:69], s53, v47
	s_nop 0
	s_or_b64 vcc, vcc, s[68:69]
	v_cmp_ne_u32 s[68:69], s53, v51
	s_nop 0
	s_or_b64 vcc, vcc, s[68:69]
	v_cmp_ne_u32 s[68:69], s53, v55
	s_nop 0
	s_or_b64 vcc, vcc, s[68:69]
	v_cmp_ne_u32 s[68:69], s53, v59
	s_nop 0
	s_or_b64 vcc, vcc, s[68:69]
	v_cmp_ne_u32 s[68:69], s53, v63
	s_nop 0
	s_or_b64 vcc, vcc, s[68:69]
	v_cmp_ne_u32 s[68:69], s53, v67
	s_nop 0
	s_or_b64 vcc, vcc, s[68:69]
	v_cmp_ne_u32 s[68:69], s53, v71
	s_nop 0
	s_or_b64 vcc, vcc, s[68:69]
	v_cmp_ne_u32 s[68:69], s53, v75
	s_nop 0
	s_or_b64 vcc, vcc, s[68:69]
	v_cmp_ne_u32 s[68:69], s53, v79
	s_nop 0
	s_or_b64 vcc, vcc, s[68:69]
	s_cbranch_vccz L_kvp_done_13
	v_min_u32 v14, 15, v1
	v_lshlrev_b32 v14, 12, v14
	v_add_u32 v14, s35, v14
	s_mov_b32 s64, 200000
L_kvp_probe_10:
	buffer_load_dword v15, v14, s[44:47], 0 offen offset:12 sc1
	s_waitcnt vmcnt(0)
	v_cmp_ne_u32 vcc, s53, v15
	s_cbranch_vccz L_kvp_seen_11
	s_sub_u32 s64, s64, 1
	s_cmp_lg_u32 s64, 0
	s_cbranch_scc1 L_kvp_probe_10
L_kvp_seen_11:
L_kvp_full_12:
	s_mov_b32 s65, s35
	buffer_load_dwordx4 v[16:19], v2, s[44:47], s65 offen sc1
	s_add_u32 s65, s65, 4096
	buffer_load_dwordx4 v[20:23], v2, s[44:47], s65 offen sc1
	s_add_u32 s65, s65, 4096
	buffer_load_dwordx4 v[24:27], v2, s[44:47], s65 offen sc1
	s_add_u32 s65, s65, 4096
	buffer_load_dwordx4 v[28:31], v2, s[44:47], s65 offen sc1
	s_add_u32 s65, s65, 4096
	buffer_load_dwordx4 v[32:35], v2, s[44:47], s65 offen sc1
	s_add_u32 s65, s65, 4096
	buffer_load_dwordx4 v[36:39], v2, s[44:47], s65 offen sc1
	s_add_u32 s65, s65, 4096
	buffer_load_dwordx4 v[40:43], v2, s[44:47], s65 offen sc1
	s_add_u32 s65, s65, 4096
	buffer_load_dwordx4 v[44:47], v2, s[44:47], s65 offen sc1
	s_add_u32 s65, s65, 4096
	buffer_load_dwordx4 v[48:51], v2, s[44:47], s65 offen sc1
	s_add_u32 s65, s65, 4096
	buffer_load_dwordx4 v[52:55], v2, s[44:47], s65 offen sc1
	s_add_u32 s65, s65, 4096
	buffer_load_dwordx4 v[56:59], v2, s[44:47], s65 offen sc1
	s_add_u32 s65, s65, 4096
	buffer_load_dwordx4 v[60:63], v2, s[44:47], s65 offen sc1
	s_add_u32 s65, s65, 4096
	buffer_load_dwordx4 v[64:67], v2, s[44:47], s65 offen sc1
	s_add_u32 s65, s65, 4096
	buffer_load_dwordx4 v[68:71], v2, s[44:47], s65 offen sc1
	s_add_u32 s65, s65, 4096
	buffer_load_dwordx4 v[72:75], v2, s[44:47], s65 offen sc1
	s_add_u32 s65, s65, 4096
	buffer_load_dwordx4 v[76:79], v2, s[44:47], s65 offen sc1
	s_waitcnt vmcnt(0)
	v_cmp_ne_u32 vcc, s53, v19
	v_cmp_ne_u32 s[68:69], s53, v23
	s_nop 0
	s_or_b64 vcc, vcc, s[68:69]
	v_cmp_ne_u32 s[68:69], s53, v27
	s_nop 0
	s_or_b64 vcc, vcc, s[68:69]
	v_cmp_ne_u32 s[68:69], s53, v31
	s_nop 0
	s_or_b64 vcc, vcc, s[68:69]
	v_cmp_ne_u32 s[68:69], s53, v35
	s_nop 0
	s_or_b64 vcc, vcc, s[68:69]
	v_cmp_ne_u32 s[68:69], s53, v39
	s_nop 0
	s_or_b64 vcc, vcc, s[68:69]
	v_cmp_ne_u32 s[68:69], s53, v43
	s_nop 0
	s_or_b64 vcc, vcc, s[68:69]
	v_cmp_ne_u32 s[68:69], s53, v47
	s_nop 0
	s_or_b64 vcc, vcc, s[68:69]
	v_cmp_ne_u32 s[68:69], s53, v51
	s_nop 0
	s_or_b64 vcc, vcc, s[68:69]
	v_cmp_ne_u32 s[68:69], s53, v55
	s_nop 0
	s_or_b64 vcc, vcc, s[68:69]
	v_cmp_ne_u32 s[68:69], s53, v59
	s_nop 0
	s_or_b64 vcc, vcc, s[68:69]
	v_cmp_ne_u32 s[68:69], s53, v63
	s_nop 0
	s_or_b64 vcc, vcc, s[68:69]
	v_cmp_ne_u32 s[68:69], s53, v67
	s_nop 0
	s_or_b64 vcc, vcc, s[68:69]
	v_cmp_ne_u32 s[68:69], s53, v71
	s_nop 0
	s_or_b64 vcc, vcc, s[68:69]
	v_cmp_ne_u32 s[68:69], s53, v75
	s_nop 0
	s_or_b64 vcc, vcc, s[68:69]
	v_cmp_ne_u32 s[68:69], s53, v79
	s_nop 0
	s_or_b64 vcc, vcc, s[68:69]
	s_cbranch_vccz L_kvp_done_13
	s_sub_u32 s64, s64, 1
	s_cmp_lg_u32 s64, 0
	s_cbranch_scc1 L_kvp_full_12
L_kvp_done_13:
	s_and_b32 s55, s71, 7
	s_lshl_b32 s55, s55, 7
	v_lshrrev_b32 v12, 3, v1
	v_lshlrev_b32 v12, 10, v12
	v_and_b32 v13, 7, v1
	v_bfe_u32 v14, v1, 4, 1
	v_lshlrev_b32 v14, 2, v14
	v_xor_b32 v13, v13, v14
	v_lshl_add_u32 v12, v13, 4, v12
	v_add_u32 v12, s55, v12
	s_lshl_b32 s58, s52, 17
	s_lshl_b32 s59, s52, 14
	v_dot2c_f32_bf16 v176, v16, v10
	v_dot2c_f32_bf16 v177, v16, v11
	v_dot2c_f32_bf16 v178, v17, v10
	v_dot2c_f32_bf16 v179, v17, v11
	v_dot2c_f32_bf16 v176, v20, v10
	v_dot2c_f32_bf16 v177, v20, v11
	v_dot2c_f32_bf16 v178, v21, v10
	v_dot2c_f32_bf16 v179, v21, v11
	s_add_u32 s65, s58, 0
	s_add_u32 m0, s59, 0
	s_nop 0
	buffer_load_dwordx4 v12, s[16:19], s65 offen lds
	v_dot2c_f32_bf16 v176, v24, v10
	v_dot2c_f32_bf16 v177, v24, v11
	v_dot2c_f32_bf16 v178, v25, v10
	v_dot2c_f32_bf16 v179, v25, v11
	v_dot2c_f32_bf16 v176, v28, v10
	v_dot2c_f32_bf16 v177, v28, v11
	v_dot2c_f32_bf16 v178, v29, v10
	v_dot2c_f32_bf16 v179, v29, v11
	s_add_u32 s65, s58, 8192
	s_add_u32 m0, s59, 1024
	s_nop 0
	buffer_load_dwordx4 v12, s[16:19], s65 offen lds
	v_dot2c_f32_bf16 v176, v32, v10
	v_dot2c_f32_bf16 v177, v32, v11
	v_dot2c_f32_bf16 v178, v33, v10
	v_dot2c_f32_bf16 v179, v33, v11
	v_dot2c_f32_bf16 v176, v36, v10
	v_dot2c_f32_bf16 v177, v36, v11
	v_dot2c_f32_bf16 v178, v37, v10
	v_dot2c_f32_bf16 v179, v37, v11
	s_add_u32 s65, s58, 16384
	s_add_u32 m0, s59, 2048
	s_nop 0
	buffer_load_dwordx4 v12, s[16:19], s65 offen lds
	v_dot2c_f32_bf16 v176, v40, v10
	v_dot2c_f32_bf16 v177, v40, v11
	v_dot2c_f32_bf16 v178, v41, v10
	v_dot2c_f32_bf16 v179, v41, v11
	v_dot2c_f32_bf16 v176, v44, v10
	v_dot2c_f32_bf16 v177, v44, v11
	v_dot2c_f32_bf16 v178, v45, v10
	v_dot2c_f32_bf16 v179, v45, v11
	s_add_u32 s65, s58, 24576
	s_add_u32 m0, s59, 3072
	s_nop 0
	buffer_load_dwordx4 v12, s[16:19], s65 offen lds
	v_dot2c_f32_bf16 v176, v48, v10
	v_dot2c_f32_bf16 v177, v48, v11
	v_dot2c_f32_bf16 v178, v49, v10
	v_dot2c_f32_bf16 v179, v49, v11
	v_dot2c_f32_bf16 v176, v52, v10
	v_dot2c_f32_bf16 v177, v52, v11
	v_dot2c_f32_bf16 v178, v53, v10
	v_dot2c_f32_bf16 v179, v53, v11
	s_add_u32 s65, s58, 32768
	s_add_u32 m0, s59, 4096
	s_nop 0
	buffer_load_dwordx4 v12, s[16:19], s65 offen lds
	v_dot2c_f32_bf16 v176, v56, v10
	v_dot2c_f32_bf16 v177, v56, v11
	v_dot2c_f32_bf16 v178, v57, v10
	v_dot2c_f32_bf16 v179, v57, v11
	v_dot2c_f32_bf16 v176, v60, v10
	v_dot2c_f32_bf16 v177, v60, v11
	v_dot2c_f32_bf16 v178, v61, v10
	v_dot2c_f32_bf16 v179, v61, v11
	s_add_u32 s65, s58, 40960
	s_add_u32 m0, s59, 5120
	s_nop 0
	buffer_load_dwordx4 v12, s[16:19], s65 offen lds
	v_dot2c_f32_bf16 v176, v64, v10
	v_dot2c_f32_bf16 v177, v64, v11
	v_dot2c_f32_bf16 v178, v65, v10
	v_dot2c_f32_bf16 v179, v65, v11
	v_dot2c_f32_bf16 v176, v68, v10
	v_dot2c_f32_bf16 v177, v68, v11
	v_dot2c_f32_bf16 v178, v69, v10
	v_dot2c_f32_bf16 v179, v69, v11
	s_add_u32 s65, s58, 49152
	s_add_u32 m0, s59, 6144
	s_nop 0
	buffer_load_dwordx4 v12, s[16:19], s65 offen lds
	v_dot2c_f32_bf16 v176, v72, v10
	v_dot2c_f32_bf16 v177, v72, v11
	v_dot2c_f32_bf16 v178, v73, v10
	v_dot2c_f32_bf16 v179, v73, v11
	v_dot2c_f32_bf16 v176, v76, v10
	v_dot2c_f32_bf16 v177, v76, v11
	v_dot2c_f32_bf16 v178, v77, v10
	v_dot2c_f32_bf16 v179, v77, v11
	s_add_u32 s65, s58, 57344
	s_add_u32 m0, s59, 7168
	s_nop 0
	buffer_load_dwordx4 v12, s[16:19], s65 offen lds
	s_cmp_eq_u32 s52, 0
	s_cbranch_scc0 L_zsum_14
	v_dot2c_f32_bf16 v180, v18, v10
	v_dot2c_f32_bf16 v181, v18, v11
	v_dot2c_f32_bf16 v180, v22, v10
	v_dot2c_f32_bf16 v181, v22, v11
	v_dot2c_f32_bf16 v180, v26, v10
	v_dot2c_f32_bf16 v181, v26, v11
	v_dot2c_f32_bf16 v180, v30, v10
	v_dot2c_f32_bf16 v181, v30, v11
	v_dot2c_f32_bf16 v180, v34, v10
	v_dot2c_f32_bf16 v181, v34, v11
	v_dot2c_f32_bf16 v180, v38, v10
	v_dot2c_f32_bf16 v181, v38, v11
	v_dot2c_f32_bf16 v180, v42, v10
	v_dot2c_f32_bf16 v181, v42, v11
	v_dot2c_f32_bf16 v180, v46, v10
	v_dot2c_f32_bf16 v181, v46, v11
	v_dot2c_f32_bf16 v180, v50, v10
	v_dot2c_f32_bf16 v181, v50, v11
	v_dot2c_f32_bf16 v180, v54, v10
	v_dot2c_f32_bf16 v181, v54, v11
	v_dot2c_f32_bf16 v180, v58, v10
	v_dot2c_f32_bf16 v181, v58, v11
	v_dot2c_f32_bf16 v180, v62, v10
	v_dot2c_f32_bf16 v181, v62, v11
	v_dot2c_f32_bf16 v180, v66, v10
	v_dot2c_f32_bf16 v181, v66, v11
	v_dot2c_f32_bf16 v180, v70, v10
	v_dot2c_f32_bf16 v181, v70, v11
	v_dot2c_f32_bf16 v180, v74, v10
	v_dot2c_f32_bf16 v181, v74, v11
	v_dot2c_f32_bf16 v180, v78, v10
	v_dot2c_f32_bf16 v181, v78, v11
L_zsum_14:
	s_nop 2
	v_mov_b32 v160, v176
	v_mov_b32 v161, v177
	v_mov_b32 v162, v178
	v_mov_b32 v163, v179
	v_mov_b32 v164, v180
	v_mov_b32 v165, v181
	v_cvt_pk_bf16_f32 v160, v160, v161
	v_cvt_pk_bf16_f32 v161, v162, v163
	v_lshlrev_b32 v8, 5, v1
	s_lshl_b32 s55, s52, 3
	s_add_u32 s55, s55, 149504
	v_add_u32 v8, s55, v8
	ds_write_b64 v8, v[160:161]
	v_mov_b32 v166, v164
	s_nop 1
	v_permlane32_swap_b32 v164, v166
	v_add_f32 v164, v164, v166
	v_mov_b32 v166, v165
	s_nop 1
	v_permlane32_swap_b32 v165, v166
	v_add_f32 v165, v165, v166
	v_cvt_pk_bf16_f32 v164, v164, v165
	v_bfe_u32 v8, v1, 2, 1
	v_bfe_u32 v9, v1, 3, 2
	v_and_b32 v10, 3, v1
	v_lshl_add_u32 v9, v9, 2, v10
	v_lshlrev_b32 v9, 1, v9
	v_lshl_add_u32 v10, v8, 5, v9
	v_add_u32 v10, 151552, v10
	v_xor_b32 v8, 1, v8
	v_lshl_add_u32 v11, v8, 5, v9
	v_add_u32 v11, 151616, v11
	s_cmp_eq_u32 s52, 0
	s_cbranch_scc0 L_zw_15
	ds_write_b16 v10, v164
	ds_write_b16_d16_hi v11, v164
L_zw_15:
	s_add_u32 s65, s58, 65536
	s_add_u32 m0, s59, 8192
	s_nop 0
	buffer_load_dwordx4 v12, s[16:19], s65 offen lds
	s_add_u32 s65, s58, 73728
	s_add_u32 m0, s59, 9216
	s_nop 0
	buffer_load_dwordx4 v12, s[16:19], s65 offen lds
	s_add_u32 s65, s58, 81920
	s_add_u32 m0, s59, 10240
	s_nop 0
	buffer_load_dwordx4 v12, s[16:19], s65 offen lds
	s_add_u32 s65, s58, 90112
	s_add_u32 m0, s59, 11264
	s_nop 0
	buffer_load_dwordx4 v12, s[16:19], s65 offen lds
	s_waitcnt lgkmcnt(0)
	s_barrier
	v_lshlrev_b32 v8, 5, v1
	v_add_u32 v8, 149504, v8
	v_xor_b32 v9, 32, v1
	v_lshlrev_b32 v9, 5, v9
	v_add_u32 v9, 149504, v9
	v_mov_b32 v10, 154624
	v_cndmask_b32 v8, v10, v8, s[66:67]
	v_cndmask_b32 v9, v10, v9, s[66:67]
	v_lshrrev_b32 v10, 5, v1
	v_lshlrev_b32 v10, 5, v10
	v_add_u32 v10, 151552, v10
	ds_read_b128 v[112:115], v8
	ds_read_b128 v[116:119], v8 offset:16
	ds_read_b128 v[120:123], v9
	ds_read_b128 v[124:127], v9 offset:16
	ds_read_b128 v[128:131], v10
	ds_read_b128 v[132:135], v10 offset:16
	ds_read_b128 v[136:139], v10 offset:64
	ds_read_b128 v[140:143], v10 offset:80
	s_waitcnt lgkmcnt(0)
	s_add_u32 s65, s58, 98304
	s_add_u32 m0, s59, 12288
	s_nop 0
	buffer_load_dwordx4 v12, s[16:19], s65 offen lds
	s_add_u32 s65, s58, 106496
	s_add_u32 m0, s59, 13312
	s_nop 0
	buffer_load_dwordx4 v12, s[16:19], s65 offen lds
	s_add_u32 s65, s58, 114688
	s_add_u32 m0, s59, 14336
	s_nop 0
	buffer_load_dwordx4 v12, s[16:19], s65 offen lds
	s_add_u32 s65, s58, 122880
	s_add_u32 m0, s59, 15360
	s_nop 0
	buffer_load_dwordx4 v12, s[16:19], s65 offen lds
	v_mfma_f32_32x32x16_bf16 v[144:159], v[112:115], v[96:99], 0
	v_mfma_f32_32x32x16_bf16 v[144:159], v[116:119], v[100:103], v[144:159]
	v_mfma_f32_32x32x16_bf16 v[144:159], v[120:123], v[104:107], v[144:159]
	v_mfma_f32_32x32x16_bf16 v[144:159], v[124:127], v[108:111], v[144:159]
	v_mov_b32 v10, 0
	v_mov_b32 v11, 0
	v_dot2c_f32_bf16 v10, v96, v128
	v_dot2c_f32_bf16 v11, v104, v136
	v_dot2c_f32_bf16 v10, v97, v129
	v_dot2c_f32_bf16 v11, v105, v137
	v_dot2c_f32_bf16 v10, v98, v130
	v_dot2c_f32_bf16 v11, v106, v138
	v_dot2c_f32_bf16 v10, v99, v131
	v_dot2c_f32_bf16 v11, v107, v139
	v_dot2c_f32_bf16 v10, v100, v132
	v_dot2c_f32_bf16 v11, v108, v140
	v_dot2c_f32_bf16 v10, v101, v133
	v_dot2c_f32_bf16 v11, v109, v141
	v_dot2c_f32_bf16 v10, v102, v134
	v_dot2c_f32_bf16 v11, v110, v142
	v_dot2c_f32_bf16 v10, v103, v135
	v_dot2c_f32_bf16 v11, v111, v143
	s_nop 2
	v_add_f32 v10, v10, v11
	v_add_f32 v10, 0x358637bd, v10
	v_rcp_f32 v10, v10
	s_nop 0
	v_pk_mul_f32 v[144:145], v[144:145], v[10:11] op_sel_hi:[1,0]
	v_pk_mul_f32 v[146:147], v[146:147], v[10:11] op_sel_hi:[1,0]
	v_pk_mul_f32 v[148:149], v[148:149], v[10:11] op_sel_hi:[1,0]
	v_pk_mul_f32 v[150:151], v[150:151], v[10:11] op_sel_hi:[1,0]
	v_pk_mul_f32 v[152:153], v[152:153], v[10:11] op_sel_hi:[1,0]
	v_pk_mul_f32 v[154:155], v[154:155], v[10:11] op_sel_hi:[1,0]
	v_pk_mul_f32 v[156:157], v[156:157], v[10:11] op_sel_hi:[1,0]
	v_pk_mul_f32 v[158:159], v[158:159], v[10:11] op_sel_hi:[1,0]
	v_cvt_pk_bf16_f32 v160, v144, v145
	v_cvt_pk_bf16_f32 v161, v146, v147
	v_cvt_pk_bf16_f32 v162, v148, v149
	v_cvt_pk_bf16_f32 v163, v150, v151
	v_cvt_pk_bf16_f32 v164, v152, v153
	v_cvt_pk_bf16_f32 v165, v154, v155
	v_cvt_pk_bf16_f32 v166, v156, v157
	v_cvt_pk_bf16_f32 v167, v158, v159
	s_lshl_b32 s55, s50, 2
	s_add_u32 s55, s55, s52
	s_lshl_b32 s55, s55, 15
	s_lshl_b32 s56, s51, 11
	s_add_u32 s55, s55, s56
	s_add_u32 s55, s55, 2097152
	v_add_u32 v8, s55, v2
	buffer_store_dwordx4 v[160:163], v8, s[44:47], 0 offen sc1
	buffer_store_dwordx4 v[164:167], v8, s[44:47], 0 offen offset:1024 sc1
	s_waitcnt vmcnt(0)
	s_lshl_b32 s55, s50, 4
	s_add_u32 s55, s55, s51
	s_lshl_b32 s55, s55, 7
	s_add_u32 s55, s55, 49152
	s_barrier
	s_cmp_eq_u32 s52, 0
	s_cbranch_scc0 L_fo_sig_16
	v_mov_b32 v14, s55
	s_mov_b64 exec, 1
	buffer_store_dword v3, v14, s[44:47], 0 offen sc1
	s_mov_b64 exec, -1
L_fo_sig_16:
	s_cmp_eq_u32 s52, 1
	s_cbranch_scc0 L_cpf_17
	v_min_u32 v12, 11, v1
	v_lshlrev_b32 v12, 7, v12
	v_min_u32 v12, s101, v12
	v_mov_b32 v13, s1
	v_add_co_u32 v12, vcc, s0, v12
	s_nop 1
	v_addc_co_u32 v13, vcc, 0, v13, vcc
	global_load_dword v0, v[12:13], off
L_cpf_17:
	v_and_b32 v12, 31, v1
	v_lshlrev_b32 v12, 10, v12
	v_lshrrev_b32 v13, 5, v1
	v_lshl_add_u32 v12, v13, 5, v12
	s_lshl_b32 s55, s98, 15
	s_lshl_b32 s56, s99, 6
	s_add_u32 s55, s55, s56
	v_add_u32 v12, s55, v12
	buffer_load_dwordx4 v[64:67], v12, s[4:7], 0 offen
	buffer_load_dwordx4 v[68:71], v12, s[4:7], 0 offen offset:16
	v_lshrrev_b32 v8, 5, v1
	v_bfe_u32 v11, v1, 4, 1
	v_bfe_u32 v9, v1, 2, 2
	v_and_b32 v10, 3, v1
	v_and_b32 v13, 1, v10
	v_lshlrev_b32 v13, 5, v13
	v_lshrrev_b32 v14, 1, v10
	v_lshlrev_b32 v14, 3, v14
	v_lshl_add_u32 v12, v11, 4, v13
	v_add_u32 v12, v12, v14
	v_mul_u32_u24 v8, 16, v8
	v_add_u32 v8, v8, v9
	v_lshlrev_b32 v8, 7, v8
	v_lshrrev_b32 v9, 1, v9
	v_xor_b32 v9, s97, v9
	v_lshl_add_u32 v8, v9, 6, v8
	v_add_u32 v15, v8, v12
	ds_read_b64_tr_b16 a[0:1], v15 offset:0
	ds_read_b64_tr_b16 a[2:3], v15 offset:512
	ds_read_b64_tr_b16 a[4:5], v15 offset:1024
	ds_read_b64_tr_b16 a[6:7], v15 offset:1536
	ds_read_b64_tr_b16 a[8:9], v15 offset:4096
	ds_read_b64_tr_b16 a[10:11], v15 offset:4608
	ds_read_b64_tr_b16 a[12:13], v15 offset:5120
	ds_read_b64_tr_b16 a[14:15], v15 offset:5632
	s_waitcnt lgkmcnt(6)
	ds_read_b64_tr_b16 a[16:17], v15 offset:8192
	ds_read_b64_tr_b16 a[18:19], v15 offset:8704
	ds_read_b64_tr_b16 a[20:21], v15 offset:9216
	ds_read_b64_tr_b16 a[22:23], v15 offset:9728
	ds_read_b64_tr_b16 a[24:25], v15 offset:12288
	ds_read_b64_tr_b16 a[26:27], v15 offset:12800
	ds_read_b64_tr_b16 a[28:29], v15 offset:13312
	ds_read_b64_tr_b16 a[30:31], v15 offset:13824
	s_waitcnt lgkmcnt(6)
	ds_read_b64_tr_b16 a[32:33], v15 offset:16384
	ds_read_b64_tr_b16 a[34:35], v15 offset:16896
	ds_read_b64_tr_b16 a[36:37], v15 offset:17408
	ds_read_b64_tr_b16 a[38:39], v15 offset:17920
	ds_read_b64_tr_b16 a[40:41], v15 offset:20480
	ds_read_b64_tr_b16 a[42:43], v15 offset:20992
	ds_read_b64_tr_b16 a[44:45], v15 offset:21504
	ds_read_b64_tr_b16 a[46:47], v15 offset:22016
	s_waitcnt lgkmcnt(6)
	ds_read_b64_tr_b16 a[48:49], v15 offset:24576
	ds_read_b64_tr_b16 a[50:51], v15 offset:25088
	ds_read_b64_tr_b16 a[52:53], v15 offset:25600
	ds_read_b64_tr_b16 a[54:55], v15 offset:26112
	ds_read_b64_tr_b16 a[56:57], v15 offset:28672
	ds_read_b64_tr_b16 a[58:59], v15 offset:29184
	ds_read_b64_tr_b16 a[60:61], v15 offset:29696
	ds_read_b64_tr_b16 a[62:63], v15 offset:30208
	s_waitcnt lgkmcnt(6)
	ds_read_b64_tr_b16 a[64:65], v15 offset:32768
	ds_read_b64_tr_b16 a[66:67], v15 offset:33280
	ds_read_b64_tr_b16 a[68:69], v15 offset:33792
	ds_read_b64_tr_b16 a[70:71], v15 offset:34304
	ds_read_b64_tr_b16 a[72:73], v15 offset:36864
	ds_read_b64_tr_b16 a[74:75], v15 offset:37376
	ds_read_b64_tr_b16 a[76:77], v15 offset:37888
	ds_read_b64_tr_b16 a[78:79], v15 offset:38400
	s_waitcnt lgkmcnt(6)
	ds_read_b64_tr_b16 a[80:81], v15 offset:40960
	ds_read_b64_tr_b16 a[82:83], v15 offset:41472
	ds_read_b64_tr_b16 a[84:85], v15 offset:41984
	ds_read_b64_tr_b16 a[86:87], v15 offset:42496
	ds_read_b64_tr_b16 a[88:89], v15 offset:45056
	ds_read_b64_tr_b16 a[90:91], v15 offset:45568
	ds_read_b64_tr_b16 a[92:93], v15 offset:46080
	ds_read_b64_tr_b16 a[94:95], v15 offset:46592
	s_waitcnt lgkmcnt(6)
	ds_read_b64_tr_b16 a[96:97], v15 offset:49152
	ds_read_b64_tr_b16 a[98:99], v15 offset:49664
	ds_read_b64_tr_b16 a[100:101], v15 offset:50176
	ds_read_b64_tr_b16 a[102:103], v15 offset:50688
	ds_read_b64_tr_b16 a[104:105], v15 offset:53248
	ds_read_b64_tr_b16 a[106:107], v15 offset:53760
	ds_read_b64_tr_b16 a[108:109], v15 offset:54272
	ds_read_b64_tr_b16 a[110:111], v15 offset:54784
	s_waitcnt lgkmcnt(6)
	ds_read_b64_tr_b16 a[112:113], v15 offset:57344
	ds_read_b64_tr_b16 a[114:115], v15 offset:57856
	ds_read_b64_tr_b16 a[116:117], v15 offset:58368
	ds_read_b64_tr_b16 a[118:119], v15 offset:58880
	ds_read_b64_tr_b16 a[120:121], v15 offset:61440
	ds_read_b64_tr_b16 a[122:123], v15 offset:61952
	ds_read_b64_tr_b16 a[124:125], v15 offset:62464
	ds_read_b64_tr_b16 a[126:127], v15 offset:62976
	s_waitcnt lgkmcnt(6)
	s_waitcnt lgkmcnt(0)
	s_sub_u32 s55, s2, 64
	s_cmp_ge_u32 s55, 128
	s_cbranch_scc1 L_mn_c_18
	s_cmp_eq_u32 s52, 2
	s_cbranch_scc0 L_mn_c_18
	v_lshrrev_b32 v8, 4, v1
	v_lshlrev_b32 v8, 3, v8
	v_add_u32 v8, 158720, v8
	v_lshlrev_b32 v10, 3, v1
	v_add_u32 v10, 114688, v10
	ds_read_b64_tr_b16 v[116:117], v10 offset:0
	ds_read_b64_tr_b16 v[118:119], v10 offset:512
	ds_read_b64 v[112:113], v8 offset:0
	ds_read_b64 v[114:115], v8 offset:32
	ds_read_b64_tr_b16 v[124:125], v10 offset:1024
	ds_read_b64_tr_b16 v[126:127], v10 offset:1536
	ds_read_b64 v[120:121], v8 offset:64
	ds_read_b64 v[122:123], v8 offset:96
	ds_read_b64_tr_b16 v[132:133], v10 offset:2048
	ds_read_b64_tr_b16 v[134:135], v10 offset:2560
	ds_read_b64 v[128:129], v8 offset:128
	ds_read_b64 v[130:131], v8 offset:160
	s_waitcnt lgkmcnt(8)
	v_mfma_f32_16x16x32_bf16 v[144:147], v[112:115], v[116:119], 0
	ds_read_b64_tr_b16 v[140:141], v10 offset:3072
	ds_read_b64_tr_b16 v[142:143], v10 offset:3584
	ds_read_b64 v[136:137], v8 offset:192
	ds_read_b64 v[138:139], v8 offset:224
	s_waitcnt lgkmcnt(8)
	v_mfma_f32_16x16x32_bf16 v[148:151], v[120:123], v[124:127], 0
	ds_read_b64_tr_b16 v[116:117], v10 offset:4096
	ds_read_b64_tr_b16 v[118:119], v10 offset:4608
	ds_read_b64 v[112:113], v8 offset:256
	ds_read_b64 v[114:115], v8 offset:288
	s_waitcnt lgkmcnt(8)
	v_mfma_f32_16x16x32_bf16 v[144:147], v[128:131], v[132:135], v[144:147]
	ds_read_b64_tr_b16 v[124:125], v10 offset:5120
	ds_read_b64_tr_b16 v[126:127], v10 offset:5632
	ds_read_b64 v[120:121], v8 offset:320
	ds_read_b64 v[122:123], v8 offset:352
	s_waitcnt lgkmcnt(8)
	v_mfma_f32_16x16x32_bf16 v[148:151], v[136:139], v[140:143], v[148:151]
	ds_read_b64_tr_b16 v[132:133], v10 offset:6144
	ds_read_b64_tr_b16 v[134:135], v10 offset:6656
	ds_read_b64 v[128:129], v8 offset:384
	ds_read_b64 v[130:131], v8 offset:416
	s_waitcnt lgkmcnt(8)
	v_mfma_f32_16x16x32_bf16 v[144:147], v[112:115], v[116:119], v[144:147]
	ds_read_b64_tr_b16 v[140:141], v10 offset:7168
	ds_read_b64_tr_b16 v[142:143], v10 offset:7680
	ds_read_b64 v[136:137], v8 offset:448
	ds_read_b64 v[138:139], v8 offset:480
	s_waitcnt lgkmcnt(8)
	v_mfma_f32_16x16x32_bf16 v[148:151], v[120:123], v[124:127], v[148:151]
	ds_read_b64_tr_b16 v[116:117], v10 offset:8192
	ds_read_b64_tr_b16 v[118:119], v10 offset:8704
	ds_read_b64 v[112:113], v8 offset:512
	ds_read_b64 v[114:115], v8 offset:544
	s_waitcnt lgkmcnt(8)
	v_mfma_f32_16x16x32_bf16 v[144:147], v[128:131], v[132:135], v[144:147]
	ds_read_b64_tr_b16 v[124:125], v10 offset:9216
	ds_read_b64_tr_b16 v[126:127], v10 offset:9728
	ds_read_b64 v[120:121], v8 offset:576
	ds_read_b64 v[122:123], v8 offset:608
	s_waitcnt lgkmcnt(8)
	v_mfma_f32_16x16x32_bf16 v[148:151], v[136:139], v[140:143], v[148:151]
	ds_read_b64_tr_b16 v[132:133], v10 offset:10240
	ds_read_b64_tr_b16 v[134:135], v10 offset:10752
	ds_read_b64 v[128:129], v8 offset:640
	ds_read_b64 v[130:131], v8 offset:672
	s_waitcnt lgkmcnt(8)
	v_mfma_f32_16x16x32_bf16 v[144:147], v[112:115], v[116:119], v[144:147]
	ds_read_b64_tr_b16 v[140:141], v10 offset:11264
	ds_read_b64_tr_b16 v[142:143], v10 offset:11776
	ds_read_b64 v[136:137], v8 offset:704
	ds_read_b64 v[138:139], v8 offset:736
	s_waitcnt lgkmcnt(8)
	v_mfma_f32_16x16x32_bf16 v[148:151], v[120:123], v[124:127], v[148:151]
	ds_read_b64_tr_b16 v[116:117], v10 offset:12288
	ds_read_b64_tr_b16 v[118:119], v10 offset:12800
	ds_read_b64 v[112:113], v8 offset:768
	ds_read_b64 v[114:115], v8 offset:800
	s_waitcnt lgkmcnt(8)
	v_mfma_f32_16x16x32_bf16 v[144:147], v[128:131], v[132:135], v[144:147]
	ds_read_b64_tr_b16 v[124:125], v10 offset:13312
	ds_read_b64_tr_b16 v[126:127], v10 offset:13824
	ds_read_b64 v[120:121], v8 offset:832
	ds_read_b64 v[122:123], v8 offset:864
	s_waitcnt lgkmcnt(8)
	v_mfma_f32_16x16x32_bf16 v[148:151], v[136:139], v[140:143], v[148:151]
	ds_read_b64_tr_b16 v[132:133], v10 offset:14336
	ds_read_b64_tr_b16 v[134:135], v10 offset:14848
	ds_read_b64 v[128:129], v8 offset:896
	ds_read_b64 v[130:131], v8 offset:928
	s_waitcnt lgkmcnt(8)
	v_mfma_f32_16x16x32_bf16 v[144:147], v[112:115], v[116:119], v[144:147]
	ds_read_b64_tr_b16 v[140:141], v10 offset:15360
	ds_read_b64_tr_b16 v[142:143], v10 offset:15872
	ds_read_b64 v[136:137], v8 offset:960
	ds_read_b64 v[138:139], v8 offset:992
	s_waitcnt lgkmcnt(8)
	v_mfma_f32_16x16x32_bf16 v[148:151], v[120:123], v[124:127], v[148:151]
	s_waitcnt lgkmcnt(4)
	v_mfma_f32_16x16x32_bf16 v[144:147], v[128:131], v[132:135], v[144:147]
	s_waitcnt lgkmcnt(0)
	v_mfma_f32_16x16x32_bf16 v[148:151], v[136:139], v[140:143], v[148:151]
	s_nop 7
	v_add_f32 v144, v144, v148
	s_nop 1
	v_mov_b32_dpp v145, v144 quad_perm:[1,0,3,2] row_mask:0xf bank_mask:0xf
	v_cvt_pk_bf16_f32 v144, v144, v145
	v_mov_b32 v145, v3
	v_lshlrev_b32 v8, 2, v1
	s_lshl_b32 s55, s100, 6
	s_add_u32 s55, s55, 4096
	v_add_u32 v8, s55, v8
	s_mov_b64 exec, 0x5555
	buffer_store_dwordx2 v[144:145], v8, s[44:47], 0 offen sc1
	s_mov_b64 exec, -1
L_mn_c_18:
	s_and_b32 s55, s52, 1
	s_cmp_eq_u32 s55, 0
	s_cselect_b32 s92, s20, s24
	s_cselect_b32 s93, s21, s25
	s_cselect_b32 s94, s22, s26
	s_cselect_b32 s95, s23, s27
	v_add_u32 v14, 0, v1
	v_mul_u32_u24 v15, 4682, v14
	v_lshrrev_b32 v15, 16, v15
	v_mul_u32_u24 v4, 14, v15
	v_sub_u32 v14, v14, v4
	v_mul_u32_u24 v15, 3584, v15
	v_lshl_add_u32 v15, v14, 4, v15
	s_mul_i32 s55, s51, 224
	v_add_u32 v4, s55, v15
	v_add_u32 v14, 64, v1
	v_mul_u32_u24 v15, 4682, v14
	v_lshrrev_b32 v15, 16, v15
	v_mul_u32_u24 v5, 14, v15
	v_sub_u32 v14, v14, v5
	v_mul_u32_u24 v15, 3584, v15
	v_lshl_add_u32 v15, v14, 4, v15
	s_mul_i32 s55, s51, 224
	v_add_u32 v5, s55, v15
	v_add_u32 v14, 128, v1
	v_mul_u32_u24 v15, 4682, v14
	v_lshrrev_b32 v15, 16, v15
	v_mul_u32_u24 v6, 14, v15
	v_sub_u32 v14, v14, v6
	v_mul_u32_u24 v15, 3584, v15
	v_lshl_add_u32 v15, v14, 4, v15
	s_mul_i32 s55, s51, 224
	v_add_u32 v6, s55, v15
	v_add_u32 v14, 192, v1
	v_mul_u32_u24 v15, 4682, v14
	v_lshrrev_b32 v15, 16, v15
	v_mul_u32_u24 v7, 14, v15
	v_sub_u32 v14, v14, v7
	v_mul_u32_u24 v15, 3584, v15
	v_lshl_add_u32 v15, v14, 4, v15
	s_mul_i32 s55, s51, 224
	v_add_u32 v7, s55, v15
	v_add_u32 v14, 256, v1
	v_mul_u32_u24 v15, 4682, v14
	v_lshrrev_b32 v15, 16, v15
	v_mul_u32_u24 v8, 14, v15
	v_sub_u32 v14, v14, v8
	v_mul_u32_u24 v15, 3584, v15
	v_lshl_add_u32 v15, v14, 4, v15
	s_mul_i32 s55, s51, 224
	v_add_u32 v8, s55, v15
	v_add_u32 v14, 320, v1
	v_mul_u32_u24 v15, 4682, v14
	v_lshrrev_b32 v15, 16, v15
	v_mul_u32_u24 v9, 14, v15
	v_sub_u32 v14, v14, v9
	v_mul_u32_u24 v15, 3584, v15
	v_lshl_add_u32 v15, v14, 4, v15
	s_mul_i32 s55, s51, 224
	v_add_u32 v9, s55, v15
	v_add_u32 v14, 384, v1
	v_mul_u32_u24 v15, 4682, v14
	v_lshrrev_b32 v15, 16, v15
	v_mul_u32_u24 v10, 14, v15
	v_sub_u32 v14, v14, v10
	v_mul_u32_u24 v15, 3584, v15
	v_lshl_add_u32 v15, v14, 4, v15
	s_mul_i32 s55, s51, 224
	v_add_u32 v10, s55, v15
	s_lshr_b32 s55, s52, 1
	s_mul_i32 s90, s55, 14592
	s_and_b32 s56, s52, 1
	s_mul_i32 s56, s56, 7296
	s_add_u32 s90, s90, s56
	s_mul_i32 s91, s55, 114688
	v_lshrrev_b32 v13, 5, v1
	v_lshlrev_b32 v13, 6, v13
	s_lshl_b32 s55, s99, 7
	s_add_u32 s55, s55, 4096
	v_add_u32 v13, s55, v13
	v_add_u32 v12, 4096, v13
	v_add_u32 v13, 8192, v13
	s_lshl_b32 s55, s70, 11
	s_add_u32 s55, s55, 49152
	s_cmp_eq_u32 s52, 0
	s_cbranch_scc0 L_po_skip_19
	v_min_u32 v14, 15, v1
	v_lshlrev_b32 v14, 7, v14
	v_add_u32 v14, s55, v14
	s_mov_b32 s64, 200000
L_po_loop_20:
	buffer_load_dword v15, v14, s[44:47], 0 offen sc1
	s_waitcnt vmcnt(0)
	v_cmp_ne_u32 vcc, s53, v15
	s_cbranch_vccz L_po_ok_21
	s_sub_u32 s64, s64, 1
	s_cmp_lg_u32 s64, 0
	s_cbranch_scc1 L_po_loop_20
L_po_ok_21:
L_po_skip_19:
	s_barrier
	s_sub_u32 s55, s98, s96
	s_lshl_b32 s55, s55, 15
	s_lshl_b32 s56, s52, 14
	s_add_u32 s57, s55, s56
	s_add_u32 s57, s57, 2097152
	s_add_u32 s58, s56, 98304
	s_and_b32 s59, s71, 7
	s_lshl_b32 s59, s59, 11
	s_add_u32 s55, s59, 0
	s_and_b32 s55, s55, 0x3fff
	s_add_u32 m0, s58, s55
	s_add_u32 s65, s57, s55
	buffer_load_dwordx4 v2, s[44:47], s65 offen sc1 lds
	s_add_u32 s55, s59, 1024
	s_and_b32 s55, s55, 0x3fff
	s_add_u32 m0, s58, s55
	s_add_u32 s65, s57, s55
	buffer_load_dwordx4 v2, s[44:47], s65 offen sc1 lds
	s_add_u32 s55, s59, 2048
	s_and_b32 s55, s55, 0x3fff
	s_add_u32 m0, s58, s55
	s_add_u32 s65, s57, s55
	buffer_load_dwordx4 v2, s[44:47], s65 offen sc1 lds
	s_add_u32 s55, s59, 3072
	s_and_b32 s55, s55, 0x3fff
	s_add_u32 m0, s58, s55
	s_add_u32 s65, s57, s55
	buffer_load_dwordx4 v2, s[44:47], s65 offen sc1 lds
	s_add_u32 s55, s59, 4096
	s_and_b32 s55, s55, 0x3fff
	s_add_u32 m0, s58, s55
	s_add_u32 s65, s57, s55
	buffer_load_dwordx4 v2, s[44:47], s65 offen sc1 lds
	s_add_u32 s55, s59, 5120
	s_and_b32 s55, s55, 0x3fff
	s_add_u32 m0, s58, s55
	s_add_u32 s65, s57, s55
	buffer_load_dwordx4 v2, s[44:47], s65 offen sc1 lds
	s_add_u32 s55, s59, 6144
	s_and_b32 s55, s55, 0x3fff
	s_add_u32 m0, s58, s55
	s_add_u32 s65, s57, s55
	buffer_load_dwordx4 v2, s[44:47], s65 offen sc1 lds
	s_add_u32 s55, s59, 7168
	s_and_b32 s55, s55, 0x3fff
	s_add_u32 m0, s58, s55
	s_add_u32 s65, s57, s55
	buffer_load_dwordx4 v2, s[44:47], s65 offen sc1 lds
	s_add_u32 s55, s59, 8192
	s_and_b32 s55, s55, 0x3fff
	s_add_u32 m0, s58, s55
	s_add_u32 s65, s57, s55
	buffer_load_dwordx4 v2, s[44:47], s65 offen sc1 lds
	s_add_u32 s55, s59, 9216
	s_and_b32 s55, s55, 0x3fff
	s_add_u32 m0, s58, s55
	s_add_u32 s65, s57, s55
	buffer_load_dwordx4 v2, s[44:47], s65 offen sc1 lds
	s_add_u32 s55, s59, 10240
	s_and_b32 s55, s55, 0x3fff
	s_add_u32 m0, s58, s55
	s_add_u32 s65, s57, s55
	buffer_load_dwordx4 v2, s[44:47], s65 offen sc1 lds
	s_add_u32 s55, s59, 11264
	s_and_b32 s55, s55, 0x3fff
	s_add_u32 m0, s58, s55
	s_add_u32 s65, s57, s55
	buffer_load_dwordx4 v2, s[44:47], s65 offen sc1 lds
	s_add_u32 s55, s59, 12288
	s_and_b32 s55, s55, 0x3fff
	s_add_u32 m0, s58, s55
	s_add_u32 s65, s57, s55
	buffer_load_dwordx4 v2, s[44:47], s65 offen sc1 lds
	s_add_u32 s55, s59, 13312
	s_and_b32 s55, s55, 0x3fff
	s_add_u32 m0, s58, s55
	s_add_u32 s65, s57, s55
	buffer_load_dwordx4 v2, s[44:47], s65 offen sc1 lds
	s_add_u32 s55, s59, 14336
	s_and_b32 s55, s55, 0x3fff
	s_add_u32 m0, s58, s55
	s_add_u32 s65, s57, s55
	buffer_load_dwordx4 v2, s[44:47], s65 offen sc1 lds
	s_add_u32 s55, s59, 15360
	s_and_b32 s55, s55, 0x3fff
	s_add_u32 m0, s58, s55
	s_add_u32 s65, s57, s55
	buffer_load_dwordx4 v2, s[44:47], s65 offen sc1 lds
	buffer_load_dwordx4 v[72:75], v12, s[44:47], 0 offen offset:0 sc1
	buffer_load_dwordx4 v[76:79], v12, s[44:47], 0 offen offset:16 sc1
	buffer_load_dwordx4 v[80:83], v12, s[44:47], 0 offen offset:32 sc1
	buffer_load_dwordx4 v[84:87], v12, s[44:47], 0 offen offset:48 sc1
	buffer_load_dwordx4 v[88:91], v13, s[44:47], 0 offen offset:0 sc1
	buffer_load_dwordx4 v[92:95], v13, s[44:47], 0 offen offset:16 sc1
	buffer_load_dwordx4 v[96:99], v13, s[44:47], 0 offen offset:32 sc1
	buffer_load_dwordx4 v[100:103], v13, s[44:47], 0 offen offset:48 sc1
	s_add_u32 m0, s90, 0
	s_add_u32 s65, s91, 0
	buffer_load_dwordx4 v4, s[92:95], s65 offen lds
	s_add_u32 m0, s90, 1024
	s_nop 0
	buffer_load_dwordx4 v5, s[92:95], s65 offen lds
	s_add_u32 m0, s90, 2048
	s_nop 0
	buffer_load_dwordx4 v6, s[92:95], s65 offen lds
	s_add_u32 m0, s90, 3072
	s_nop 0
	buffer_load_dwordx4 v7, s[92:95], s65 offen lds
	s_add_u32 m0, s90, 4096
	s_nop 0
	buffer_load_dwordx4 v8, s[92:95], s65 offen lds
	s_add_u32 m0, s90, 5120
	s_nop 0
	buffer_load_dwordx4 v9, s[92:95], s65 offen lds
	s_lshl_b32 s55, s96, 15
	s_add_u32 s55, s55, 98304
	v_add_u32 v14, s55, v2
	s_waitcnt vmcnt(14)
	s_barrier
	ds_read_b128 v[16:19], v14 offset:0
	ds_read_b128 v[20:23], v14 offset:1024
	ds_read_b128 v[24:27], v14 offset:2048
	ds_read_b128 v[28:31], v14 offset:3072
	ds_read_b128 v[32:35], v14 offset:4096
	s_waitcnt lgkmcnt(4)
	v_mfma_f32_32x32x16_bf16 v[112:127], a[0:3], v[16:19], 0
	s_add_u32 m0, s90, 6144
	s_nop 0
	buffer_load_dwordx4 v10, s[92:95], s65 offen lds
	ds_read_b128 v[36:39], v14 offset:5120
	s_waitcnt lgkmcnt(4)
	v_mfma_f32_32x32x16_bf16 v[112:127], a[4:7], v[20:23], v[112:127]
	ds_read_b128 v[16:19], v14 offset:6144
	s_waitcnt lgkmcnt(4)
	v_mfma_f32_32x32x16_bf16 v[112:127], a[8:11], v[24:27], v[112:127]
	s_add_u32 m0, s90, 29184
	s_add_u32 s65, s91, 229376
	buffer_load_dwordx4 v4, s[92:95], s65 offen lds
	ds_read_b128 v[20:23], v14 offset:7168
	s_waitcnt lgkmcnt(4)
	v_mfma_f32_32x32x16_bf16 v[112:127], a[12:15], v[28:31], v[112:127]
	ds_read_b128 v[24:27], v14 offset:8192
	s_waitcnt lgkmcnt(4)
	v_mfma_f32_32x32x16_bf16 v[112:127], a[16:19], v[32:35], v[112:127]
	s_add_u32 m0, s90, 30208
	s_nop 0
	buffer_load_dwordx4 v5, s[92:95], s65 offen lds
	ds_read_b128 v[28:31], v14 offset:9216
	s_waitcnt lgkmcnt(4)
	v_mfma_f32_32x32x16_bf16 v[112:127], a[20:23], v[36:39], v[112:127]
	ds_read_b128 v[32:35], v14 offset:10240
	s_waitcnt lgkmcnt(4)
	v_mfma_f32_32x32x16_bf16 v[112:127], a[24:27], v[16:19], v[112:127]
	s_add_u32 m0, s90, 31232
	s_nop 0
	buffer_load_dwordx4 v6, s[92:95], s65 offen lds
	s_mov_b32 s64, 200000
	s_waitcnt vmcnt(10)
	s_branch L_gacb_chk_23
L_gacb_loop_22:
	buffer_load_dwordx4 v[72:75], v12, s[44:47], 0 offen offset:0 sc1
	buffer_load_dwordx4 v[76:79], v12, s[44:47], 0 offen offset:16 sc1
	buffer_load_dwordx4 v[80:83], v12, s[44:47], 0 offen offset:32 sc1
	buffer_load_dwordx4 v[84:87], v12, s[44:47], 0 offen offset:48 sc1
	buffer_load_dwordx4 v[88:91], v13, s[44:47], 0 offen offset:0 sc1
	buffer_load_dwordx4 v[92:95], v13, s[44:47], 0 offen offset:16 sc1
	buffer_load_dwordx4 v[96:99], v13, s[44:47], 0 offen offset:32 sc1
	buffer_load_dwordx4 v[100:103], v13, s[44:47], 0 offen offset:48 sc1
	s_waitcnt vmcnt(0)
L_gacb_chk_23:
	v_cmp_ne_u32 vcc, s53, v73
	v_cmp_ne_u32 s[68:69], s53, v75
	s_nop 0
	s_or_b64 vcc, vcc, s[68:69]
	v_cmp_ne_u32 s[68:69], s53, v77
	s_nop 0
	s_or_b64 vcc, vcc, s[68:69]
	v_cmp_ne_u32 s[68:69], s53, v79
	s_nop 0
	s_or_b64 vcc, vcc, s[68:69]
	v_cmp_ne_u32 s[68:69], s53, v81
	s_nop 0
	s_or_b64 vcc, vcc, s[68:69]
	v_cmp_ne_u32 s[68:69], s53, v83
	s_nop 0
	s_or_b64 vcc, vcc, s[68:69]
	v_cmp_ne_u32 s[68:69], s53, v85
	s_nop 0
	s_or_b64 vcc, vcc, s[68:69]
	v_cmp_ne_u32 s[68:69], s53, v87
	s_nop 0
	s_or_b64 vcc, vcc, s[68:69]
	v_cmp_ne_u32 s[68:69], s53, v89
	s_nop 0
	s_or_b64 vcc, vcc, s[68:69]
	v_cmp_ne_u32 s[68:69], s53, v91
	s_nop 0
	s_or_b64 vcc, vcc, s[68:69]
	v_cmp_ne_u32 s[68:69], s53, v93
	s_nop 0
	s_or_b64 vcc, vcc, s[68:69]
	v_cmp_ne_u32 s[68:69], s53, v95
	s_nop 0
	s_or_b64 vcc, vcc, s[68:69]
	v_cmp_ne_u32 s[68:69], s53, v97
	s_nop 0
	s_or_b64 vcc, vcc, s[68:69]
	v_cmp_ne_u32 s[68:69], s53, v99
	s_nop 0
	s_or_b64 vcc, vcc, s[68:69]
	v_cmp_ne_u32 s[68:69], s53, v101
	s_nop 0
	s_or_b64 vcc, vcc, s[68:69]
	v_cmp_ne_u32 s[68:69], s53, v103
	s_nop 0
	s_or_b64 vcc, vcc, s[68:69]
	s_cbranch_vccz L_gacb_ok_24
	s_sub_u32 s64, s64, 1
	s_cmp_lg_u32 s64, 0
	s_cbranch_scc1 L_gacb_loop_22
L_gacb_ok_24:
	v_lshlrev_b32 v144, 16, v72
	v_and_b32 v145, s54, v72
	v_lshlrev_b32 v176, 16, v64
	ds_read_b128 v[36:39], v14 offset:11264
	s_waitcnt lgkmcnt(4)
	v_mfma_f32_32x32x16_bf16 v[112:127], a[28:31], v[20:23], v[112:127]
	v_and_b32 v177, s54, v64
	v_lshlrev_b32 v160, 16, v88
	v_and_b32 v161, s54, v88
	v_add_f32 v160, 1.0, v160
	ds_read_b128 v[16:19], v14 offset:12288
	s_waitcnt lgkmcnt(4)
	v_mfma_f32_32x32x16_bf16 v[112:127], a[32:35], v[24:27], v[112:127]
	s_add_u32 m0, s90, 32256
	s_nop 0
	buffer_load_dwordx4 v7, s[92:95], s65 offen lds
	v_add_f32 v161, 1.0, v161
	v_cvt_pk_bf16_f32 v88, v160, v161
	v_lshlrev_b32 v160, 16, v88
	v_and_b32 v161, s54, v88
	ds_read_b128 v[20:23], v14 offset:13312
	s_waitcnt lgkmcnt(4)
	v_mfma_f32_32x32x16_bf16 v[112:127], a[36:39], v[28:31], v[112:127]
	v_lshlrev_b32 v146, 16, v74
	v_and_b32 v147, s54, v74
	v_lshlrev_b32 v178, 16, v65
	v_and_b32 v179, s54, v65
	ds_read_b128 v[24:27], v14 offset:14336
	s_waitcnt lgkmcnt(4)
	v_mfma_f32_32x32x16_bf16 v[112:127], a[40:43], v[32:35], v[112:127]
	s_add_u32 m0, s90, 33280
	s_nop 0
	buffer_load_dwordx4 v8, s[92:95], s65 offen lds
	v_lshlrev_b32 v162, 16, v90
	v_and_b32 v163, s54, v90
	v_add_f32 v162, 1.0, v162
	v_add_f32 v163, 1.0, v163
	ds_read_b128 v[28:31], v14 offset:15360
	s_waitcnt lgkmcnt(4)
	v_mfma_f32_32x32x16_bf16 v[112:127], a[44:47], v[36:39], v[112:127]
	v_cvt_pk_bf16_f32 v90, v162, v163
	v_lshlrev_b32 v162, 16, v90
	v_and_b32 v163, s54, v90
	v_lshlrev_b32 v148, 16, v76
	ds_read_b128 v[32:35], v14 offset:16384
	s_waitcnt lgkmcnt(4)
	v_mfma_f32_32x32x16_bf16 v[112:127], a[48:51], v[16:19], v[112:127]
	s_add_u32 m0, s90, 34304
	s_nop 0
	buffer_load_dwordx4 v9, s[92:95], s65 offen lds
	v_and_b32 v149, s54, v76
	v_lshlrev_b32 v180, 16, v66
	v_and_b32 v181, s54, v66
	v_lshlrev_b32 v164, 16, v92
	ds_read_b128 v[36:39], v14 offset:17408
	s_waitcnt lgkmcnt(4)
	v_mfma_f32_32x32x16_bf16 v[112:127], a[52:55], v[20:23], v[112:127]
	v_and_b32 v165, s54, v92
	v_add_f32 v164, 1.0, v164
	v_add_f32 v165, 1.0, v165
	v_cvt_pk_bf16_f32 v92, v164, v165
	ds_read_b128 v[16:19], v14 offset:18432
	s_waitcnt lgkmcnt(4)
	v_mfma_f32_32x32x16_bf16 v[112:127], a[56:59], v[24:27], v[112:127]
	s_add_u32 m0, s90, 35328
	s_nop 0
	buffer_load_dwordx4 v10, s[92:95], s65 offen lds
	v_lshlrev_b32 v164, 16, v92
	v_and_b32 v165, s54, v92
	v_lshlrev_b32 v150, 16, v78
	v_and_b32 v151, s54, v78
	ds_read_b128 v[20:23], v14 offset:19456
	s_waitcnt lgkmcnt(4)
	v_mfma_f32_32x32x16_bf16 v[112:127], a[60:63], v[28:31], v[112:127]
	v_lshlrev_b32 v182, 16, v67
	v_and_b32 v183, s54, v67
	v_lshlrev_b32 v166, 16, v94
	v_and_b32 v167, s54, v94
	ds_read_b128 v[24:27], v14 offset:20480
	s_waitcnt lgkmcnt(4)
	v_mfma_f32_32x32x16_bf16 v[112:127], a[64:67], v[32:35], v[112:127]
	s_add_u32 m0, s90, 58368
	s_add_u32 s65, s91, 458752
	buffer_load_dwordx4 v4, s[92:95], s65 offen lds
	v_add_f32 v166, 1.0, v166
	v_add_f32 v167, 1.0, v167
	v_cvt_pk_bf16_f32 v94, v166, v167
	v_lshlrev_b32 v166, 16, v94
	ds_read_b128 v[28:31], v14 offset:21504
	s_waitcnt lgkmcnt(4)
	v_mfma_f32_32x32x16_bf16 v[112:127], a[68:71], v[36:39], v[112:127]
	v_and_b32 v167, s54, v94
	v_lshlrev_b32 v152, 16, v80
	v_and_b32 v153, s54, v80
	v_lshlrev_b32 v184, 16, v68
	ds_read_b128 v[32:35], v14 offset:22528
	s_waitcnt lgkmcnt(4)
	v_mfma_f32_32x32x16_bf16 v[112:127], a[72:75], v[16:19], v[112:127]
	s_add_u32 m0, s90, 59392
	s_nop 0
	buffer_load_dwordx4 v5, s[92:95], s65 offen lds
	v_and_b32 v185, s54, v68
	v_lshlrev_b32 v168, 16, v96
	v_and_b32 v169, s54, v96
	v_add_f32 v168, 1.0, v168
	ds_read_b128 v[36:39], v14 offset:23552
	s_waitcnt lgkmcnt(4)
	v_mfma_f32_32x32x16_bf16 v[112:127], a[76:79], v[20:23], v[112:127]
	v_add_f32 v169, 1.0, v169
	v_cvt_pk_bf16_f32 v96, v168, v169
	v_lshlrev_b32 v168, 16, v96
	v_and_b32 v169, s54, v96
	ds_read_b128 v[16:19], v14 offset:24576
	s_waitcnt lgkmcnt(4)
	v_mfma_f32_32x32x16_bf16 v[112:127], a[80:83], v[24:27], v[112:127]
	s_add_u32 m0, s90, 60416
	s_nop 0
	buffer_load_dwordx4 v6, s[92:95], s65 offen lds
	v_lshlrev_b32 v154, 16, v82
	v_and_b32 v155, s54, v82
	v_lshlrev_b32 v186, 16, v69
	v_and_b32 v187, s54, v69
	ds_read_b128 v[20:23], v14 offset:25600
	s_waitcnt lgkmcnt(4)
	v_mfma_f32_32x32x16_bf16 v[112:127], a[84:87], v[28:31], v[112:127]
	v_lshlrev_b32 v170, 16, v98
	v_and_b32 v171, s54, v98
	v_add_f32 v170, 1.0, v170
	v_add_f32 v171, 1.0, v171
	ds_read_b128 v[24:27], v14 offset:26624
	s_waitcnt lgkmcnt(4)
	v_mfma_f32_32x32x16_bf16 v[112:127], a[88:91], v[32:35], v[112:127]
	s_add_u32 m0, s90, 61440
	s_nop 0
	buffer_load_dwordx4 v7, s[92:95], s65 offen lds
	v_cvt_pk_bf16_f32 v98, v170, v171
	v_lshlrev_b32 v170, 16, v98
	v_and_b32 v171, s54, v98
	v_lshlrev_b32 v156, 16, v84
	ds_read_b128 v[28:31], v14 offset:27648
	s_waitcnt lgkmcnt(4)
	v_mfma_f32_32x32x16_bf16 v[112:127], a[92:95], v[36:39], v[112:127]
	v_and_b32 v157, s54, v84
	v_lshlrev_b32 v188, 16, v70
	v_and_b32 v189, s54, v70
	v_lshlrev_b32 v172, 16, v100
	ds_read_b128 v[32:35], v14 offset:28672
	s_waitcnt lgkmcnt(4)
	v_mfma_f32_32x32x16_bf16 v[112:127], a[96:99], v[16:19], v[112:127]
	s_add_u32 m0, s90, 62464
	s_nop 0
	buffer_load_dwordx4 v8, s[92:95], s65 offen lds
	v_and_b32 v173, s54, v100
	v_add_f32 v172, 1.0, v172
	v_add_f32 v173, 1.0, v173
	v_cvt_pk_bf16_f32 v100, v172, v173
	ds_read_b128 v[36:39], v14 offset:29696
	s_waitcnt lgkmcnt(4)
	v_mfma_f32_32x32x16_bf16 v[112:127], a[100:103], v[20:23], v[112:127]
	v_lshlrev_b32 v172, 16, v100
	v_and_b32 v173, s54, v100
	v_lshlrev_b32 v158, 16, v86
	v_and_b32 v159, s54, v86
	ds_read_b128 v[16:19], v14 offset:30720
	s_waitcnt lgkmcnt(4)
	v_mfma_f32_32x32x16_bf16 v[112:127], a[104:107], v[24:27], v[112:127]
	s_add_u32 m0, s90, 63488
	s_nop 0
	buffer_load_dwordx4 v9, s[92:95], s65 offen lds
	v_lshlrev_b32 v190, 16, v71
	v_and_b32 v191, s54, v71
	v_lshlrev_b32 v174, 16, v102
	v_and_b32 v175, s54, v102
	ds_read_b128 v[20:23], v14 offset:31744
	s_waitcnt lgkmcnt(4)
	v_mfma_f32_32x32x16_bf16 v[112:127], a[108:111], v[28:31], v[112:127]
	v_add_f32 v174, 1.0, v174
	v_add_f32 v175, 1.0, v175
	v_cvt_pk_bf16_f32 v102, v174, v175
	v_lshlrev_b32 v174, 16, v102
	s_waitcnt lgkmcnt(3)
	v_mfma_f32_32x32x16_bf16 v[112:127], a[112:115], v[32:35], v[112:127]
	s_add_u32 m0, s90, 64512
	s_nop 0
	buffer_load_dwordx4 v10, s[92:95], s65 offen lds
	v_and_b32 v175, s54, v102
	s_waitcnt lgkmcnt(2)
	v_mfma_f32_32x32x16_bf16 v[112:127], a[116:119], v[36:39], v[112:127]
	s_waitcnt lgkmcnt(1)
	v_mfma_f32_32x32x16_bf16 v[112:127], a[120:123], v[16:19], v[112:127]
	s_waitcnt lgkmcnt(0)
	v_mfma_f32_32x32x16_bf16 v[112:127], a[124:127], v[20:23], v[112:127]
	s_barrier
	v_mov_b32 v40, 0
	v_mov_b32 v41, 0
	v_mov_b32 v42, 0x3f803f80
	s_nop 7
	v_fmac_f32 v176, v144, v112
	v_fmac_f32 v177, v145, v113
	v_fmac_f32 v178, v146, v114
	v_fmac_f32 v179, v147, v115
	v_fmac_f32 v180, v148, v116
	v_fmac_f32 v181, v149, v117
	v_fmac_f32 v182, v150, v118
	v_fmac_f32 v183, v151, v119
	v_fmac_f32 v184, v152, v120
	v_fmac_f32 v185, v153, v121
	v_fmac_f32 v186, v154, v122
	v_fmac_f32 v187, v155, v123
	v_fmac_f32 v188, v156, v124
	v_fmac_f32 v189, v157, v125
	v_fmac_f32 v190, v158, v126
	v_fmac_f32 v191, v159, v127
	v_cvt_pk_bf16_f32 v136, v176, v177
	v_cvt_pk_bf16_f32 v137, v178, v179
	v_cvt_pk_bf16_f32 v138, v180, v181
	v_cvt_pk_bf16_f32 v139, v182, v183
	v_cvt_pk_bf16_f32 v140, v184, v185
	v_cvt_pk_bf16_f32 v141, v186, v187
	v_cvt_pk_bf16_f32 v142, v188, v189
	v_cvt_pk_bf16_f32 v143, v190, v191
	s_add_u32 m0, s90, 87552
	s_add_u32 s65, s91, 688128
	buffer_load_dwordx4 v4, s[92:95], s65 offen lds
	s_add_u32 m0, s90, 88576
	s_nop 0
	buffer_load_dwordx4 v5, s[92:95], s65 offen lds
	v_lshlrev_b32 v176, 16, v136
	v_and_b32 v177, s54, v136
	v_lshlrev_b32 v178, 16, v137
	v_and_b32 v179, s54, v137
	v_lshlrev_b32 v180, 16, v138
	v_and_b32 v181, s54, v138
	v_lshlrev_b32 v182, 16, v139
	v_and_b32 v183, s54, v139
	v_lshlrev_b32 v184, 16, v140
	v_and_b32 v185, s54, v140
	v_lshlrev_b32 v186, 16, v141
	v_and_b32 v187, s54, v141
	v_lshlrev_b32 v188, 16, v142
	v_and_b32 v189, s54, v142
	v_lshlrev_b32 v190, 16, v143
	v_and_b32 v191, s54, v143
	v_pk_mul_f32 v[176:177], v[176:177], v[160:161]
	v_pk_mul_f32 v[178:179], v[178:179], v[162:163]
	v_pk_mul_f32 v[180:181], v[180:181], v[164:165]
	v_pk_mul_f32 v[182:183], v[182:183], v[166:167]
	v_pk_mul_f32 v[184:185], v[184:185], v[168:169]
	v_pk_mul_f32 v[186:187], v[186:187], v[170:171]
	v_pk_mul_f32 v[188:189], v[188:189], v[172:173]
	v_pk_mul_f32 v[190:191], v[190:191], v[174:175]
	v_cvt_pk_bf16_f32 v128, v176, v177
	v_cvt_pk_bf16_f32 v129, v178, v179
	v_cvt_pk_bf16_f32 v130, v180, v181
	v_cvt_pk_bf16_f32 v131, v182, v183
	v_cvt_pk_bf16_f32 v132, v184, v185
	v_cvt_pk_bf16_f32 v133, v186, v187
	v_cvt_pk_bf16_f32 v134, v188, v189
	v_cvt_pk_bf16_f32 v135, v190, v191
	s_lshl_b32 s55, s98, 15
	s_lshl_b32 s56, s99, 11
	s_add_u32 s55, s55, s56
	s_add_u32 s55, s55, 4194304
	v_add_u32 v12, s55, v2
	buffer_store_dwordx4 v[128:131], v12, s[44:47], 0 offen sc1
	buffer_store_dwordx4 v[132:135], v12, s[44:47], 0 offen offset:1024 sc1
	v_dot2c_f32_bf16 v40, v136, v42
	v_dot2c_f32_bf16 v41, v136, v136
	v_dot2c_f32_bf16 v40, v137, v42
	v_dot2c_f32_bf16 v41, v137, v137
	v_dot2c_f32_bf16 v40, v138, v42
	v_dot2c_f32_bf16 v41, v138, v138
	v_dot2c_f32_bf16 v40, v139, v42
	v_dot2c_f32_bf16 v41, v139, v139
	v_dot2c_f32_bf16 v40, v140, v42
	v_dot2c_f32_bf16 v41, v140, v140
	v_dot2c_f32_bf16 v40, v141, v42
	v_dot2c_f32_bf16 v41, v141, v141
	v_dot2c_f32_bf16 v40, v142, v42
	v_dot2c_f32_bf16 v41, v142, v142
	v_dot2c_f32_bf16 v40, v143, v42
	v_dot2c_f32_bf16 v41, v143, v143
	s_nop 1
	v_mov_b32 v43, v40
	s_nop 1
	v_permlane32_swap_b32 v40, v43
	v_add_f32 v40, v40, v43
	v_mov_b32 v43, v41
	s_nop 1
	v_permlane32_swap_b32 v41, v43
	v_add_f32 v41, v41, v43
	s_lshl_b32 s55, s98, 4
	s_add_u32 s55, s55, s99
	s_lshl_b32 s55, s55, 8
	s_add_u32 s55, s55, 524288
	v_lshlrev_b32 v12, 3, v1
	v_add_u32 v12, s55, v12
	s_mov_b32 exec_hi, 0
	buffer_store_dwordx2 v[40:41], v12, s[44:47], 0 offen sc1
	s_mov_b64 exec, -1
	s_add_u32 m0, s90, 89600
	s_nop 0
	buffer_load_dwordx4 v6, s[92:95], s65 offen lds
	s_add_u32 m0, s90, 90624
	s_nop 0
	buffer_load_dwordx4 v7, s[92:95], s65 offen lds
	s_add_u32 m0, s90, 91648
	s_nop 0
	buffer_load_dwordx4 v8, s[92:95], s65 offen lds
	s_add_u32 m0, s90, 92672
	s_nop 0
	buffer_load_dwordx4 v9, s[92:95], s65 offen lds
	s_add_u32 m0, s90, 93696
	s_nop 0
	buffer_load_dwordx4 v10, s[92:95], s65 offen lds
	s_add_u32 m0, s90, 116736
	s_add_u32 s65, s91, 917504
	buffer_load_dwordx4 v4, s[92:95], s65 offen lds
	s_add_u32 m0, s90, 117760
	s_nop 0
	buffer_load_dwordx4 v5, s[92:95], s65 offen lds
	s_add_u32 m0, s90, 118784
	s_nop 0
	buffer_load_dwordx4 v6, s[92:95], s65 offen lds
	v_accvgpr_write_b32 a248, v136
	v_accvgpr_write_b32 a249, v137
	v_accvgpr_write_b32 a250, v138
	v_accvgpr_write_b32 a251, v139
	v_accvgpr_write_b32 a252, v140
	v_accvgpr_write_b32 a253, v141
	v_accvgpr_write_b32 a254, v142
	v_accvgpr_write_b32 a255, v143
	s_waitcnt vmcnt(8)
	s_lshl_b32 s55, s70, 4
	s_add_u32 s55, s55, s71
	s_lshl_b32 s55, s55, 7
	s_add_u32 s55, s55, 81920
	s_barrier
	s_cmp_eq_u32 s52, 0
	s_cbranch_scc0 L_fy_sig_25
	v_mov_b32 v14, s55
	s_mov_b64 exec, 1
	buffer_store_dword v3, v14, s[44:47], 0 offen sc1
	s_mov_b64 exec, -1
L_fy_sig_25:
	s_cmp_eq_u32 s2, 0
	s_cbranch_scc0 L_noepoch_26
	s_cmp_eq_u32 s52, 0
	s_cbranch_scc0 L_noepoch_26
	v_mov_b32 v12, 0
	s_mov_b64 exec, 1
	buffer_store_dword v3, v12, s[44:47], 0 offen sc1
	s_mov_b64 exec, -1
L_noepoch_26:
	s_add_u32 m0, s90, 119808
	s_nop 0
	buffer_load_dwordx4 v7, s[92:95], s65 offen lds
	s_add_u32 m0, s90, 120832
	s_nop 0
	buffer_load_dwordx4 v8, s[92:95], s65 offen lds
	s_add_u32 m0, s90, 121856
	s_nop 0
	buffer_load_dwordx4 v9, s[92:95], s65 offen lds
	s_add_u32 m0, s90, 122880
	s_nop 0
	buffer_load_dwordx4 v10, s[92:95], s65 offen lds
	s_cmp_ge_u32 s49, 28
	s_cbranch_scc1 L_ubc_skip_27
	s_cmp_lt_u32 s52, 2
	s_cbranch_scc1 L_ubc_skip_27
	s_lshr_b32 s55, s48, 1
	s_mul_i32 s57, s55, 28
	s_add_u32 s57, s57, s49
	s_cmp_ge_u32 s57, 56
	s_cselect_b32 s58, 1, 0
	s_mul_i32 s55, s58, 56
	s_sub_u32 s59, s57, s55
	s_cmp_lt_u32 s59, 28
	s_cselect_b32 s12, s20, s24
	s_cselect_b32 s13, s21, s25
	s_cselect_b32 s14, s22, s26
	s_cselect_b32 s15, s23, s27
	s_cselect_b32 s55, 0, 28
	s_cselect_b32 s56, 0, 56
	s_sub_u32 s59, s59, s55
	s_and_b32 s55, s48, 1
	s_mul_i32 s55, s55, 28
	s_add_u32 s59, s59, s55
	s_add_u32 s57, s59, s56
	v_lshrrev_b32 v112, 2, v1
	v_mul_u32_u24 v112, 3584, v112
	v_and_b32 v113, 3, v1
	v_lshl_add_u32 v112, v113, 4, v112
	s_lshl_b32 s55, s59, 6
	v_add_u32 v112, s55, v112
	s_mul_i32 s65, s58, 917504
	s_and_b32 s55, s52, 1
	s_mul_i32 s56, s55, 458752
	s_add_u32 s65, s65, s56
	s_lshl_b32 s32, s55, 13
	s_add_u32 m0, s32, 145920
	s_nop 0
	buffer_load_dwordx4 v112, s[12:15], s65 offen lds
	s_add_u32 m0, m0, 1024
	s_add_u32 s65, s65, 57344
	buffer_load_dwordx4 v112, s[12:15], s65 offen lds
	s_add_u32 m0, m0, 1024
	s_add_u32 s65, s65, 57344
	buffer_load_dwordx4 v112, s[12:15], s65 offen lds
	s_add_u32 m0, m0, 1024
	s_add_u32 s65, s65, 57344
	buffer_load_dwordx4 v112, s[12:15], s65 offen lds
	s_add_u32 m0, m0, 1024
	s_add_u32 s65, s65, 57344
	buffer_load_dwordx4 v112, s[12:15], s65 offen lds
	s_add_u32 m0, m0, 1024
	s_add_u32 s65, s65, 57344
	buffer_load_dwordx4 v112, s[12:15], s65 offen lds
	s_add_u32 m0, m0, 1024
	s_add_u32 s65, s65, 57344
	buffer_load_dwordx4 v112, s[12:15], s65 offen lds
	s_add_u32 m0, m0, 1024
	s_add_u32 s65, s65, 57344
	buffer_load_dwordx4 v112, s[12:15], s65 offen lds
	s_lshl_b32 s55, s58, 10
	v_add_u32 v114, s55, v2
	v_add_u32 v114, 10240, v114
	buffer_load_dwordx4 v[116:119], v114, s[44:47], 0 offen offset:0 sc1
	buffer_load_dwordx4 v[120:123], v114, s[44:47], 0 offen offset:2048 sc1
	s_mov_b32 s64, 200000
	s_waitcnt vmcnt(0)
	s_branch L_modU_chk_29
L_modU_loop_28:
	buffer_load_dwordx4 v[116:119], v114, s[44:47], 0 offen offset:0 sc1
	buffer_load_dwordx4 v[120:123], v114, s[44:47], 0 offen offset:2048 sc1
	s_waitcnt vmcnt(0)
L_modU_chk_29:
	v_cmp_ne_u32 vcc, s53, v117
	v_cmp_ne_u32 s[68:69], s53, v119
	s_nop 0
	s_or_b64 vcc, vcc, s[68:69]
	v_cmp_ne_u32 s[68:69], s53, v121
	s_nop 0
	s_or_b64 vcc, vcc, s[68:69]
	v_cmp_ne_u32 s[68:69], s53, v123
	s_nop 0
	s_or_b64 vcc, vcc, s[68:69]
	s_cbranch_vccz L_modU_ok_30
	s_sub_u32 s64, s64, 1
	s_cmp_lg_u32 s64, 0
	s_cbranch_scc1 L_modU_loop_28
L_modU_ok_30:
	v_lshlrev_b32 v124, 16, v120
	v_and_b32 v125, s54, v120
	v_add_f32 v124, 1.0, v124
	v_add_f32 v125, 1.0, v125
	v_cvt_pk_bf16_f32 v128, v124, v125
	v_lshlrev_b32 v124, 16, v122
	v_and_b32 v125, s54, v122
	v_add_f32 v124, 1.0, v124
	v_add_f32 v125, 1.0, v125
	v_cvt_pk_bf16_f32 v129, v124, v125
	v_mov_b32 v130, v116
	v_mov_b32 v131, v118
	v_mov_b32 v132, 0
	v_mov_b32 v133, 0
	v_lshlrev_b32 v113, 3, v1
	v_add_u32 v113, 162304, v113
	ds_write_b64 v113, v[128:129]
	ds_write_b64 v113, v[130:131] offset:512
	ds_write_b64 v113, v[132:133] offset:1024
	v_and_b32 v113, 31, v1
	v_min_u32 v113, 2, v113
	v_lshlrev_b32 v113, 9, v113
	v_lshrrev_b32 v114, 5, v1
	v_lshl_add_u32 v113, v114, 4, v113
	v_add_u32 v113, 162304, v113
	s_lshr_b32 s55, s32, 5
	v_add_u32 v113, s55, v113
	v_lshrrev_b32 v114, 5, v1
	v_bfe_u32 v117, v1, 4, 1
	v_bfe_u32 v115, v1, 2, 2
	v_and_b32 v116, 3, v1
	v_lshl_add_u32 v114, v114, 3, v115
	v_lshlrev_b32 v114, 6, v114
	v_lshl_add_u32 v114, v117, 5, v114
	v_lshl_add_u32 v114, v116, 3, v114
	v_add_u32 v114, 145920, v114
	v_add_u32 v114, s32, v114
	s_waitcnt vmcnt(0) lgkmcnt(0)
	ds_read_b64_tr_b16 v[120:121], v114 offset:0
	ds_read_b64_tr_b16 v[122:123], v114 offset:256
	ds_read_b128 v[116:119], v113 offset:0
	ds_read_b64_tr_b16 v[128:129], v114 offset:1024
	ds_read_b64_tr_b16 v[130:131], v114 offset:1280
	ds_read_b128 v[124:127], v113 offset:32
	ds_read_b64_tr_b16 v[136:137], v114 offset:2048
	ds_read_b64_tr_b16 v[138:139], v114 offset:2304
	ds_read_b128 v[132:135], v113 offset:64
	s_waitcnt lgkmcnt(6)
	v_mfma_f32_32x32x16_bf16 v[152:167], v[116:119], v[120:123], 0
	ds_read_b64_tr_b16 v[144:145], v114 offset:3072
	ds_read_b64_tr_b16 v[146:147], v114 offset:3328
	ds_read_b128 v[140:143], v113 offset:96
	s_waitcnt lgkmcnt(6)
	v_mfma_f32_32x32x16_bf16 v[152:167], v[124:127], v[128:131], v[152:167]
	ds_read_b64_tr_b16 v[120:121], v114 offset:4096
	ds_read_b64_tr_b16 v[122:123], v114 offset:4352
	ds_read_b128 v[116:119], v113 offset:128
	s_waitcnt lgkmcnt(6)
	v_mfma_f32_32x32x16_bf16 v[152:167], v[132:135], v[136:139], v[152:167]
	ds_read_b64_tr_b16 v[128:129], v114 offset:5120
	ds_read_b64_tr_b16 v[130:131], v114 offset:5376
	ds_read_b128 v[124:127], v113 offset:160
	s_waitcnt lgkmcnt(6)
	v_mfma_f32_32x32x16_bf16 v[152:167], v[140:143], v[144:147], v[152:167]
	ds_read_b64_tr_b16 v[136:137], v114 offset:6144
	ds_read_b64_tr_b16 v[138:139], v114 offset:6400
	ds_read_b128 v[132:135], v113 offset:192
	s_waitcnt lgkmcnt(6)
	v_mfma_f32_32x32x16_bf16 v[152:167], v[116:119], v[120:123], v[152:167]
	ds_read_b64_tr_b16 v[144:145], v114 offset:7168
	ds_read_b64_tr_b16 v[146:147], v114 offset:7424
	ds_read_b128 v[140:143], v113 offset:224
	s_waitcnt lgkmcnt(6)
	v_mfma_f32_32x32x16_bf16 v[152:167], v[124:127], v[128:131], v[152:167]
	s_waitcnt lgkmcnt(3)
	v_mfma_f32_32x32x16_bf16 v[152:167], v[132:135], v[136:139], v[152:167]
	s_waitcnt lgkmcnt(0)
	v_mfma_f32_32x32x16_bf16 v[152:167], v[140:143], v[144:147], v[152:167]
	s_nop 11
	s_cmp_eq_u32 s52, 2
	s_cbranch_scc0 L_ub_w3_31
	v_lshlrev_b32 v113, 3, v1
	v_add_u32 v113, 145920, v113
	ds_write_b64 v113, v[152:153]
	s_waitcnt lgkmcnt(0)
L_ub_w3_31:
	v_accvgpr_write_b32 a244, v152
	v_accvgpr_write_b32 a245, v153
	s_mov_b32 s33, s57
	s_mov_b32 s34, s58
L_ubc_skip_27:
	v_lshrrev_b32 v14, 5, v1
	v_bfe_u32 v15, v1, 2, 2
	v_lshl_add_u32 v14, v14, 4, v15
	v_mul_u32_u24 v14, 224, v14
	v_bfe_u32 v15, v1, 4, 1
	v_mul_u32_u24 v15, 7296, v15
	v_add_u32 v14, v14, v15
	v_and_b32 v15, 1, v1
	v_lshl_add_u32 v14, v15, 4, v14
	v_bfe_u32 v15, v1, 1, 1
	v_lshl_add_u32 v11, v15, 3, v14
	v_add_u32 v12, 58368, v11
	v_add_u32 v13, 116736, v11
	s_lshl_b32 s55, s50, 11
	s_add_u32 s55, s55, 81920
	s_waitcnt vmcnt(0)
	s_cmp_eq_u32 s52, 0
	s_cbranch_scc0 L_py_skip_32
	v_min_u32 v14, 15, v1
	v_lshlrev_b32 v14, 7, v14
	v_add_u32 v14, s55, v14
	s_mov_b32 s64, 200000
L_py_loop_33:
	buffer_load_dword v15, v14, s[44:47], 0 offen sc1
	s_waitcnt vmcnt(0)
	v_cmp_ne_u32 vcc, s53, v15
	s_cbranch_vccz L_py_ok_34
	s_sub_u32 s64, s64, 1
	s_cmp_lg_u32 s64, 0
	s_cbranch_scc1 L_py_loop_33
L_py_ok_34:
L_py_skip_32:
	s_barrier
	s_lshl_b32 s57, s50, 2
	s_add_u32 s57, s57, s52
	s_lshl_b32 s58, s57, 15
	s_add_u32 s58, s58, 4194304
	buffer_load_dwordx4 v[16:19], v2, s[44:47], s58 offen offset:0 sc1
	buffer_load_dwordx4 v[20:23], v2, s[44:47], s58 offen offset:1024 sc1
	buffer_load_dwordx4 v[24:27], v2, s[44:47], s58 offen offset:2048 sc1
	buffer_load_dwordx4 v[28:31], v2, s[44:47], s58 offen offset:3072 sc1
	s_add_u32 s58, s58, 4096
	buffer_load_dwordx4 v[32:35], v2, s[44:47], s58 offen offset:0 sc1
	buffer_load_dwordx4 v[36:39], v2, s[44:47], s58 offen offset:1024 sc1
	buffer_load_dwordx4 v[40:43], v2, s[44:47], s58 offen offset:2048 sc1
	buffer_load_dwordx4 v[44:47], v2, s[44:47], s58 offen offset:3072 sc1
	s_add_u32 s58, s58, 4096
	buffer_load_dwordx4 v[48:51], v2, s[44:47], s58 offen offset:0 sc1
	buffer_load_dwordx4 v[52:55], v2, s[44:47], s58 offen offset:1024 sc1
	buffer_load_dwordx4 v[56:59], v2, s[44:47], s58 offen offset:2048 sc1
	buffer_load_dwordx4 v[60:63], v2, s[44:47], s58 offen offset:3072 sc1
	s_add_u32 s58, s58, 4096
	buffer_load_dwordx4 v[64:67], v2, s[44:47], s58 offen offset:0 sc1
	buffer_load_dwordx4 v[68:71], v2, s[44:47], s58 offen offset:1024 sc1
	s_cmp_ge_u32 s49, 28
	s_cbranch_scc1 L_ubp_skip_35
	s_cmp_eq_u32 s52, 3
	s_cbranch_scc0 L_ubp_skip_35
	v_lshlrev_b32 v174, 3, v1
	v_add_u32 v174, 145920, v174
	ds_read_b64 v[154:155], v174
	v_accvgpr_read_b32 v152, a244
	v_accvgpr_read_b32 v153, a245
	s_waitcnt lgkmcnt(0)
	v_add_f32 v152, v152, v154
	v_add_f32 v153, v153, v155
	v_cvt_pk_bf16_f32 v168, v152, v153
	v_lshlrev_b32 v170, 16, v168
	v_and_b32 v171, s54, v168
	v_sub_f32 v172, v152, v170
	v_sub_f32 v173, v153, v171
	v_cvt_pk_bf16_f32 v169, v172, v173
	s_mov_b32 s55, 0x05040100
	s_mov_b32 s56, 0x07060302
	v_perm_b32 v176, v169, v168, s55
	v_mov_b32 v177, v168
	v_perm_b32 v178, v168, v169, s56
	v_mov_b32 v179, v3
	s_mul_i32 s55, s34, 57344
	s_lshl_b32 s56, s33, 9
	s_add_u32 s55, s55, s56
	s_add_u32 s55, s55, 262144
	v_add_u32 v174, s55, v2
	s_mov_b32 exec_hi, 0
	buffer_store_dwordx4 v[176:179], v174, s[44:47], 0 offen sc1
	s_mov_b64 exec, -1
L_ubp_skip_35:
	ds_read_b64_tr_b16 a[0:1], v11 offset:0
	ds_read_b64_tr_b16 a[2:3], v11 offset:896
	ds_read_b64_tr_b16 a[4:5], v11 offset:32
	ds_read_b64_tr_b16 a[6:7], v11 offset:928
	ds_read_b64_tr_b16 a[8:9], v11 offset:64
	ds_read_b64_tr_b16 a[10:11], v11 offset:960
	ds_read_b64_tr_b16 a[12:13], v11 offset:96
	ds_read_b64_tr_b16 a[14:15], v11 offset:992
	ds_read_b64_tr_b16 a[16:17], v11 offset:128
	ds_read_b64_tr_b16 a[18:19], v11 offset:1024
	ds_read_b64_tr_b16 a[20:21], v11 offset:160
	ds_read_b64_tr_b16 a[22:23], v11 offset:1056
	ds_read_b64_tr_b16 a[24:25], v11 offset:192
	ds_read_b64_tr_b16 a[26:27], v11 offset:1088
	s_waitcnt vmcnt(13)
	s_waitcnt lgkmcnt(12)
	v_mfma_f32_32x32x16_bf16 v[144:159], a[0:3], v[16:19], 0
	ds_read_b64_tr_b16 a[28:29], v11 offset:1792
	ds_read_b64_tr_b16 a[30:31], v11 offset:2688
	buffer_load_dwordx4 v[72:75], v2, s[44:47], s58 offen offset:2048 sc1
	s_waitcnt lgkmcnt(12)
	v_mfma_f32_32x32x16_bf16 v[160:175], a[4:7], v[16:19], 0
	ds_read_b64_tr_b16 a[32:33], v11 offset:1824
	ds_read_b64_tr_b16 a[34:35], v11 offset:2720
	s_waitcnt lgkmcnt(12)
	v_mfma_f32_32x32x16_bf16 v[176:191], a[8:11], v[16:19], 0
	ds_read_b64_tr_b16 a[36:37], v11 offset:1856
	ds_read_b64_tr_b16 a[38:39], v11 offset:2752
	s_waitcnt lgkmcnt(12)
	v_mfma_f32_32x32x16_bf16 v[192:207], a[12:15], v[16:19], 0
	ds_read_b64_tr_b16 a[40:41], v11 offset:1888
	ds_read_b64_tr_b16 a[42:43], v11 offset:2784
	s_waitcnt lgkmcnt(12)
	v_mfma_f32_32x32x16_bf16 v[208:223], a[16:19], v[16:19], 0
	ds_read_b64_tr_b16 a[44:45], v11 offset:1920
	ds_read_b64_tr_b16 a[46:47], v11 offset:2816
	s_waitcnt lgkmcnt(12)
	v_mfma_f32_32x32x16_bf16 v[224:239], a[20:23], v[16:19], 0
	ds_read_b64_tr_b16 a[48:49], v11 offset:1952
	ds_read_b64_tr_b16 a[50:51], v11 offset:2848
	s_waitcnt lgkmcnt(12)
	v_mfma_f32_32x32x16_bf16 v[240:255], a[24:27], v[16:19], 0
	ds_read_b64_tr_b16 a[52:53], v11 offset:1984
	ds_read_b64_tr_b16 a[54:55], v11 offset:2880
	s_waitcnt vmcnt(13)
	s_waitcnt lgkmcnt(12)
	v_mfma_f32_32x32x16_bf16 v[144:159], a[28:31], v[20:23], v[144:159]
	ds_read_b64_tr_b16 a[0:1], v11 offset:14592
	ds_read_b64_tr_b16 a[2:3], v11 offset:15488
	buffer_load_dwordx4 v[76:79], v2, s[44:47], s58 offen offset:3072 sc1
	s_waitcnt lgkmcnt(12)
	v_mfma_f32_32x32x16_bf16 v[160:175], a[32:35], v[20:23], v[160:175]
	ds_read_b64_tr_b16 a[4:5], v11 offset:14624
	ds_read_b64_tr_b16 a[6:7], v11 offset:15520
	s_waitcnt lgkmcnt(12)
	v_mfma_f32_32x32x16_bf16 v[176:191], a[36:39], v[20:23], v[176:191]
	ds_read_b64_tr_b16 a[8:9], v11 offset:14656
	ds_read_b64_tr_b16 a[10:11], v11 offset:15552
	s_waitcnt lgkmcnt(12)
	v_mfma_f32_32x32x16_bf16 v[192:207], a[40:43], v[20:23], v[192:207]
	ds_read_b64_tr_b16 a[12:13], v11 offset:14688
	ds_read_b64_tr_b16 a[14:15], v11 offset:15584
	s_waitcnt lgkmcnt(12)
	v_mfma_f32_32x32x16_bf16 v[208:223], a[44:47], v[20:23], v[208:223]
	ds_read_b64_tr_b16 a[16:17], v11 offset:14720
	ds_read_b64_tr_b16 a[18:19], v11 offset:15616
	s_waitcnt lgkmcnt(12)
	v_mfma_f32_32x32x16_bf16 v[224:239], a[48:51], v[20:23], v[224:239]
	ds_read_b64_tr_b16 a[20:21], v11 offset:14752
	ds_read_b64_tr_b16 a[22:23], v11 offset:15648
	s_waitcnt lgkmcnt(12)
	v_mfma_f32_32x32x16_bf16 v[240:255], a[52:55], v[20:23], v[240:255]
	ds_read_b64_tr_b16 a[24:25], v11 offset:14784
	ds_read_b64_tr_b16 a[26:27], v11 offset:15680
	s_waitcnt vmcnt(13)
	s_waitcnt lgkmcnt(12)
	v_mfma_f32_32x32x16_bf16 v[144:159], a[0:3], v[24:27], v[144:159]
	ds_read_b64_tr_b16 a[28:29], v11 offset:16384
	ds_read_b64_tr_b16 a[30:31], v11 offset:17280
	s_add_u32 s58, s58, 4096
	buffer_load_dwordx4 v[80:83], v2, s[44:47], s58 offen offset:0 sc1
	s_waitcnt lgkmcnt(12)
	v_mfma_f32_32x32x16_bf16 v[160:175], a[4:7], v[24:27], v[160:175]
	ds_read_b64_tr_b16 a[32:33], v11 offset:16416
	ds_read_b64_tr_b16 a[34:35], v11 offset:17312
	s_waitcnt lgkmcnt(12)
	v_mfma_f32_32x32x16_bf16 v[176:191], a[8:11], v[24:27], v[176:191]
	ds_read_b64_tr_b16 a[36:37], v11 offset:16448
	ds_read_b64_tr_b16 a[38:39], v11 offset:17344
	s_waitcnt lgkmcnt(12)
	v_mfma_f32_32x32x16_bf16 v[192:207], a[12:15], v[24:27], v[192:207]
	ds_read_b64_tr_b16 a[40:41], v11 offset:16480
	ds_read_b64_tr_b16 a[42:43], v11 offset:17376
	s_waitcnt lgkmcnt(12)
	v_mfma_f32_32x32x16_bf16 v[208:223], a[16:19], v[24:27], v[208:223]
	ds_read_b64_tr_b16 a[44:45], v11 offset:16512
	ds_read_b64_tr_b16 a[46:47], v11 offset:17408
	s_waitcnt lgkmcnt(12)
	v_mfma_f32_32x32x16_bf16 v[224:239], a[20:23], v[24:27], v[224:239]
	ds_read_b64_tr_b16 a[48:49], v11 offset:16544
	ds_read_b64_tr_b16 a[50:51], v11 offset:17440
	s_waitcnt lgkmcnt(12)
	v_mfma_f32_32x32x16_bf16 v[240:255], a[24:27], v[24:27], v[240:255]
	ds_read_b64_tr_b16 a[52:53], v11 offset:16576
	ds_read_b64_tr_b16 a[54:55], v11 offset:17472
	s_barrier
	s_waitcnt vmcnt(13)
	s_waitcnt lgkmcnt(12)
	v_mfma_f32_32x32x16_bf16 v[144:159], a[28:31], v[28:31], v[144:159]
	ds_read_b64_tr_b16 a[0:1], v11 offset:29184
	ds_read_b64_tr_b16 a[2:3], v11 offset:30080
	buffer_load_dwordx4 v[84:87], v2, s[44:47], s58 offen offset:1024 sc1
	s_waitcnt lgkmcnt(12)
	v_mfma_f32_32x32x16_bf16 v[160:175], a[32:35], v[28:31], v[160:175]
	ds_read_b64_tr_b16 a[4:5], v11 offset:29216
	ds_read_b64_tr_b16 a[6:7], v11 offset:30112
	s_waitcnt lgkmcnt(12)
	v_mfma_f32_32x32x16_bf16 v[176:191], a[36:39], v[28:31], v[176:191]
	ds_read_b64_tr_b16 a[8:9], v11 offset:29248
	ds_read_b64_tr_b16 a[10:11], v11 offset:30144
	s_waitcnt lgkmcnt(12)
	v_mfma_f32_32x32x16_bf16 v[192:207], a[40:43], v[28:31], v[192:207]
	ds_read_b64_tr_b16 a[12:13], v11 offset:29280
	ds_read_b64_tr_b16 a[14:15], v11 offset:30176
	s_waitcnt lgkmcnt(12)
	v_mfma_f32_32x32x16_bf16 v[208:223], a[44:47], v[28:31], v[208:223]
	ds_read_b64_tr_b16 a[16:17], v11 offset:29312
	ds_read_b64_tr_b16 a[18:19], v11 offset:30208
	s_waitcnt lgkmcnt(12)
	v_mfma_f32_32x32x16_bf16 v[224:239], a[48:51], v[28:31], v[224:239]
	ds_read_b64_tr_b16 a[20:21], v11 offset:29344
	ds_read_b64_tr_b16 a[22:23], v11 offset:30240
	s_waitcnt lgkmcnt(12)
	v_mfma_f32_32x32x16_bf16 v[240:255], a[52:55], v[28:31], v[240:255]
	ds_read_b64_tr_b16 a[24:25], v11 offset:29376
	ds_read_b64_tr_b16 a[26:27], v11 offset:30272
	s_waitcnt vmcnt(13)
	s_waitcnt lgkmcnt(12)
	v_mfma_f32_32x32x16_bf16 v[144:159], a[0:3], v[32:35], v[144:159]
	ds_read_b64_tr_b16 a[28:29], v11 offset:30976
	ds_read_b64_tr_b16 a[30:31], v11 offset:31872
	buffer_load_dwordx4 v[88:91], v2, s[44:47], s58 offen offset:2048 sc1
	s_waitcnt lgkmcnt(12)
	v_mfma_f32_32x32x16_bf16 v[160:175], a[4:7], v[32:35], v[160:175]
	ds_read_b64_tr_b16 a[32:33], v11 offset:31008
	ds_read_b64_tr_b16 a[34:35], v11 offset:31904
	s_waitcnt lgkmcnt(12)
	v_mfma_f32_32x32x16_bf16 v[176:191], a[8:11], v[32:35], v[176:191]
	ds_read_b64_tr_b16 a[36:37], v11 offset:31040
	ds_read_b64_tr_b16 a[38:39], v11 offset:31936
	s_waitcnt lgkmcnt(12)
	v_mfma_f32_32x32x16_bf16 v[192:207], a[12:15], v[32:35], v[192:207]
	ds_read_b64_tr_b16 a[40:41], v11 offset:31072
	ds_read_b64_tr_b16 a[42:43], v11 offset:31968
	s_waitcnt lgkmcnt(12)
	v_mfma_f32_32x32x16_bf16 v[208:223], a[16:19], v[32:35], v[208:223]
	ds_read_b64_tr_b16 a[44:45], v11 offset:31104
	ds_read_b64_tr_b16 a[46:47], v11 offset:32000
	s_waitcnt lgkmcnt(12)
	v_mfma_f32_32x32x16_bf16 v[224:239], a[20:23], v[32:35], v[224:239]
	ds_read_b64_tr_b16 a[48:49], v11 offset:31136
	ds_read_b64_tr_b16 a[50:51], v11 offset:32032
	s_waitcnt lgkmcnt(12)
	v_mfma_f32_32x32x16_bf16 v[240:255], a[24:27], v[32:35], v[240:255]
	ds_read_b64_tr_b16 a[52:53], v11 offset:31168
	ds_read_b64_tr_b16 a[54:55], v11 offset:32064
	s_waitcnt vmcnt(13)
	s_waitcnt lgkmcnt(12)
	v_mfma_f32_32x32x16_bf16 v[144:159], a[28:31], v[36:39], v[144:159]
	ds_read_b64_tr_b16 a[0:1], v11 offset:43776
	ds_read_b64_tr_b16 a[2:3], v11 offset:44672
	buffer_load_dwordx4 v[92:95], v2, s[44:47], s58 offen offset:3072 sc1
	s_waitcnt lgkmcnt(12)
	v_mfma_f32_32x32x16_bf16 v[160:175], a[32:35], v[36:39], v[160:175]
	ds_read_b64_tr_b16 a[4:5], v11 offset:43808
	ds_read_b64_tr_b16 a[6:7], v11 offset:44704
	s_waitcnt lgkmcnt(12)
	v_mfma_f32_32x32x16_bf16 v[176:191], a[36:39], v[36:39], v[176:191]
	ds_read_b64_tr_b16 a[8:9], v11 offset:43840
	ds_read_b64_tr_b16 a[10:11], v11 offset:44736
	s_waitcnt lgkmcnt(12)
	v_mfma_f32_32x32x16_bf16 v[192:207], a[40:43], v[36:39], v[192:207]
	ds_read_b64_tr_b16 a[12:13], v11 offset:43872
	ds_read_b64_tr_b16 a[14:15], v11 offset:44768
	s_waitcnt lgkmcnt(12)
	v_mfma_f32_32x32x16_bf16 v[208:223], a[44:47], v[36:39], v[208:223]
	ds_read_b64_tr_b16 a[16:17], v11 offset:43904
	ds_read_b64_tr_b16 a[18:19], v11 offset:44800
	s_waitcnt lgkmcnt(12)
	v_mfma_f32_32x32x16_bf16 v[224:239], a[48:51], v[36:39], v[224:239]
	ds_read_b64_tr_b16 a[20:21], v11 offset:43936
	ds_read_b64_tr_b16 a[22:23], v11 offset:44832
	s_waitcnt lgkmcnt(12)
	v_mfma_f32_32x32x16_bf16 v[240:255], a[52:55], v[36:39], v[240:255]
	ds_read_b64_tr_b16 a[24:25], v11 offset:43968
	ds_read_b64_tr_b16 a[26:27], v11 offset:44864
	s_waitcnt vmcnt(13)
	s_waitcnt lgkmcnt(12)
	v_mfma_f32_32x32x16_bf16 v[144:159], a[0:3], v[40:43], v[144:159]
	ds_read_b64_tr_b16 a[28:29], v11 offset:45568
	ds_read_b64_tr_b16 a[30:31], v11 offset:46464
	s_add_u32 s58, s58, 4096
	buffer_load_dwordx4 v[96:99], v2, s[44:47], s58 offen offset:0 sc1
	s_waitcnt lgkmcnt(12)
	v_mfma_f32_32x32x16_bf16 v[160:175], a[4:7], v[40:43], v[160:175]
	ds_read_b64_tr_b16 a[32:33], v11 offset:45600
	ds_read_b64_tr_b16 a[34:35], v11 offset:46496
	s_waitcnt lgkmcnt(12)
	v_mfma_f32_32x32x16_bf16 v[176:191], a[8:11], v[40:43], v[176:191]
	ds_read_b64_tr_b16 a[36:37], v11 offset:45632
	ds_read_b64_tr_b16 a[38:39], v11 offset:46528
	s_waitcnt lgkmcnt(12)
	v_mfma_f32_32x32x16_bf16 v[192:207], a[12:15], v[40:43], v[192:207]
	ds_read_b64_tr_b16 a[40:41], v11 offset:45664
	ds_read_b64_tr_b16 a[42:43], v11 offset:46560
	s_waitcnt lgkmcnt(12)
	v_mfma_f32_32x32x16_bf16 v[208:223], a[16:19], v[40:43], v[208:223]
	ds_read_b64_tr_b16 a[44:45], v11 offset:45696
	ds_read_b64_tr_b16 a[46:47], v11 offset:46592
	s_waitcnt lgkmcnt(12)
	v_mfma_f32_32x32x16_bf16 v[224:239], a[20:23], v[40:43], v[224:239]
	ds_read_b64_tr_b16 a[48:49], v11 offset:45728
	ds_read_b64_tr_b16 a[50:51], v11 offset:46624
	s_waitcnt lgkmcnt(12)
	v_mfma_f32_32x32x16_bf16 v[240:255], a[24:27], v[40:43], v[240:255]
	ds_read_b64_tr_b16 a[52:53], v11 offset:45760
	ds_read_b64_tr_b16 a[54:55], v11 offset:46656
	s_barrier
	s_waitcnt vmcnt(13)
	s_waitcnt lgkmcnt(12)
	v_mfma_f32_32x32x16_bf16 v[144:159], a[28:31], v[44:47], v[144:159]
	ds_read_b64_tr_b16 a[0:1], v12 offset:0
	ds_read_b64_tr_b16 a[2:3], v12 offset:896
	buffer_load_dwordx4 v[100:103], v2, s[44:47], s58 offen offset:1024 sc1
	s_waitcnt lgkmcnt(12)
	v_mfma_f32_32x32x16_bf16 v[160:175], a[32:35], v[44:47], v[160:175]
	ds_read_b64_tr_b16 a[4:5], v12 offset:32
	ds_read_b64_tr_b16 a[6:7], v12 offset:928
	s_add_u32 m0, s90, 0
	s_add_u32 s65, s91, 1146880
	buffer_load_dwordx4 v4, s[92:95], s65 offen lds
	s_waitcnt lgkmcnt(12)
	v_mfma_f32_32x32x16_bf16 v[176:191], a[36:39], v[44:47], v[176:191]
	ds_read_b64_tr_b16 a[8:9], v12 offset:64
	ds_read_b64_tr_b16 a[10:11], v12 offset:960
	s_add_u32 m0, s90, 1024
	s_nop 0
	buffer_load_dwordx4 v5, s[92:95], s65 offen lds
	s_waitcnt lgkmcnt(12)
	v_mfma_f32_32x32x16_bf16 v[192:207], a[40:43], v[44:47], v[192:207]
	ds_read_b64_tr_b16 a[12:13], v12 offset:96
	ds_read_b64_tr_b16 a[14:15], v12 offset:992
	s_add_u32 m0, s90, 2048
	s_nop 0
	buffer_load_dwordx4 v6, s[92:95], s65 offen lds
	s_waitcnt lgkmcnt(12)
	v_mfma_f32_32x32x16_bf16 v[208:223], a[44:47], v[44:47], v[208:223]
	ds_read_b64_tr_b16 a[16:17], v12 offset:128
	ds_read_b64_tr_b16 a[18:19], v12 offset:1024
	s_add_u32 m0, s90, 3072
	s_nop 0
	buffer_load_dwordx4 v7, s[92:95], s65 offen lds
	s_waitcnt lgkmcnt(12)
	v_mfma_f32_32x32x16_bf16 v[224:239], a[48:51], v[44:47], v[224:239]
	ds_read_b64_tr_b16 a[20:21], v12 offset:160
	ds_read_b64_tr_b16 a[22:23], v12 offset:1056
	s_add_u32 m0, s90, 4096
	s_nop 0
	buffer_load_dwordx4 v8, s[92:95], s65 offen lds
	s_waitcnt lgkmcnt(12)
	v_mfma_f32_32x32x16_bf16 v[240:255], a[52:55], v[44:47], v[240:255]
	ds_read_b64_tr_b16 a[24:25], v12 offset:192
	ds_read_b64_tr_b16 a[26:27], v12 offset:1088
	s_add_u32 m0, s90, 5120
	s_nop 0
	buffer_load_dwordx4 v9, s[92:95], s65 offen lds
	s_waitcnt vmcnt(19)
	s_waitcnt lgkmcnt(12)
	v_mfma_f32_32x32x16_bf16 v[144:159], a[0:3], v[48:51], v[144:159]
	ds_read_b64_tr_b16 a[28:29], v12 offset:1792
	ds_read_b64_tr_b16 a[30:31], v12 offset:2688
	buffer_load_dwordx4 v[104:107], v2, s[44:47], s58 offen offset:2048 sc1
	s_waitcnt lgkmcnt(12)
	v_mfma_f32_32x32x16_bf16 v[160:175], a[4:7], v[48:51], v[160:175]
	ds_read_b64_tr_b16 a[32:33], v12 offset:1824
	ds_read_b64_tr_b16 a[34:35], v12 offset:2720
	s_add_u32 m0, s90, 6144
	s_nop 0
	buffer_load_dwordx4 v10, s[92:95], s65 offen lds
	s_waitcnt lgkmcnt(12)
	v_mfma_f32_32x32x16_bf16 v[176:191], a[8:11], v[48:51], v[176:191]
	ds_read_b64_tr_b16 a[36:37], v12 offset:1856
	ds_read_b64_tr_b16 a[38:39], v12 offset:2752
	s_waitcnt lgkmcnt(12)
	v_mfma_f32_32x32x16_bf16 v[192:207], a[12:15], v[48:51], v[192:207]
	ds_read_b64_tr_b16 a[40:41], v12 offset:1888
	ds_read_b64_tr_b16 a[42:43], v12 offset:2784
	s_waitcnt lgkmcnt(12)
	v_mfma_f32_32x32x16_bf16 v[208:223], a[16:19], v[48:51], v[208:223]
	ds_read_b64_tr_b16 a[44:45], v12 offset:1920
	ds_read_b64_tr_b16 a[46:47], v12 offset:2816
	s_waitcnt lgkmcnt(12)
	v_mfma_f32_32x32x16_bf16 v[224:239], a[20:23], v[48:51], v[224:239]
	ds_read_b64_tr_b16 a[48:49], v12 offset:1952
	ds_read_b64_tr_b16 a[50:51], v12 offset:2848
	s_waitcnt lgkmcnt(12)
	v_mfma_f32_32x32x16_bf16 v[240:255], a[24:27], v[48:51], v[240:255]
	ds_read_b64_tr_b16 a[52:53], v12 offset:1984
	ds_read_b64_tr_b16 a[54:55], v12 offset:2880
	s_waitcnt vmcnt(20)
	s_waitcnt lgkmcnt(12)
	v_mfma_f32_32x32x16_bf16 v[144:159], a[28:31], v[52:55], v[144:159]
	ds_read_b64_tr_b16 a[0:1], v12 offset:14592
	ds_read_b64_tr_b16 a[2:3], v12 offset:15488
	buffer_load_dwordx4 v[108:111], v2, s[44:47], s58 offen offset:3072 sc1
	s_waitcnt lgkmcnt(12)
	v_mfma_f32_32x32x16_bf16 v[160:175], a[32:35], v[52:55], v[160:175]
	ds_read_b64_tr_b16 a[4:5], v12 offset:14624
	ds_read_b64_tr_b16 a[6:7], v12 offset:15520
	s_waitcnt lgkmcnt(12)
	v_mfma_f32_32x32x16_bf16 v[176:191], a[36:39], v[52:55], v[176:191]
	ds_read_b64_tr_b16 a[8:9], v12 offset:14656
	ds_read_b64_tr_b16 a[10:11], v12 offset:15552
	s_waitcnt lgkmcnt(12)
	v_mfma_f32_32x32x16_bf16 v[192:207], a[40:43], v[52:55], v[192:207]
	ds_read_b64_tr_b16 a[12:13], v12 offset:14688
	ds_read_b64_tr_b16 a[14:15], v12 offset:15584
	s_waitcnt lgkmcnt(12)
	v_mfma_f32_32x32x16_bf16 v[208:223], a[44:47], v[52:55], v[208:223]
	ds_read_b64_tr_b16 a[16:17], v12 offset:14720
	ds_read_b64_tr_b16 a[18:19], v12 offset:15616
	s_waitcnt lgkmcnt(12)
	v_mfma_f32_32x32x16_bf16 v[224:239], a[48:51], v[52:55], v[224:239]
	ds_read_b64_tr_b16 a[20:21], v12 offset:14752
	ds_read_b64_tr_b16 a[22:23], v12 offset:15648
	s_waitcnt lgkmcnt(12)
	v_mfma_f32_32x32x16_bf16 v[240:255], a[52:55], v[52:55], v[240:255]
	ds_read_b64_tr_b16 a[24:25], v12 offset:14784
	ds_read_b64_tr_b16 a[26:27], v12 offset:15680
	s_waitcnt vmcnt(20)
	s_waitcnt lgkmcnt(12)
	v_mfma_f32_32x32x16_bf16 v[144:159], a[0:3], v[56:59], v[144:159]
	ds_read_b64_tr_b16 a[28:29], v12 offset:16384
	ds_read_b64_tr_b16 a[30:31], v12 offset:17280
	s_add_u32 s58, s58, 4096
	buffer_load_dwordx4 v[112:115], v2, s[44:47], s58 offen offset:0 sc1
	s_waitcnt lgkmcnt(12)
	v_mfma_f32_32x32x16_bf16 v[160:175], a[4:7], v[56:59], v[160:175]
	ds_read_b64_tr_b16 a[32:33], v12 offset:16416
	ds_read_b64_tr_b16 a[34:35], v12 offset:17312
	s_waitcnt lgkmcnt(12)
	v_mfma_f32_32x32x16_bf16 v[176:191], a[8:11], v[56:59], v[176:191]
	ds_read_b64_tr_b16 a[36:37], v12 offset:16448
	ds_read_b64_tr_b16 a[38:39], v12 offset:17344
	s_waitcnt lgkmcnt(12)
	v_mfma_f32_32x32x16_bf16 v[192:207], a[12:15], v[56:59], v[192:207]
	ds_read_b64_tr_b16 a[40:41], v12 offset:16480
	ds_read_b64_tr_b16 a[42:43], v12 offset:17376
	s_waitcnt lgkmcnt(12)
	v_mfma_f32_32x32x16_bf16 v[208:223], a[16:19], v[56:59], v[208:223]
	ds_read_b64_tr_b16 a[44:45], v12 offset:16512
	ds_read_b64_tr_b16 a[46:47], v12 offset:17408
	s_waitcnt lgkmcnt(12)
	v_mfma_f32_32x32x16_bf16 v[224:239], a[20:23], v[56:59], v[224:239]
	ds_read_b64_tr_b16 a[48:49], v12 offset:16544
	ds_read_b64_tr_b16 a[50:51], v12 offset:17440
	s_waitcnt lgkmcnt(12)
	v_mfma_f32_32x32x16_bf16 v[240:255], a[24:27], v[56:59], v[240:255]
	ds_read_b64_tr_b16 a[52:53], v12 offset:16576
	ds_read_b64_tr_b16 a[54:55], v12 offset:17472
	s_barrier
	s_waitcnt vmcnt(20)
	s_waitcnt lgkmcnt(12)
	v_mfma_f32_32x32x16_bf16 v[144:159], a[28:31], v[60:63], v[144:159]
	ds_read_b64_tr_b16 a[0:1], v12 offset:29184
	ds_read_b64_tr_b16 a[2:3], v12 offset:30080
	buffer_load_dwordx4 v[116:119], v2, s[44:47], s58 offen offset:1024 sc1
	s_waitcnt lgkmcnt(12)
	v_mfma_f32_32x32x16_bf16 v[160:175], a[32:35], v[60:63], v[160:175]
	ds_read_b64_tr_b16 a[4:5], v12 offset:29216
	ds_read_b64_tr_b16 a[6:7], v12 offset:30112
	s_add_u32 m0, s90, 29184
	s_add_u32 s65, s91, 1376256
	buffer_load_dwordx4 v4, s[92:95], s65 offen lds
	s_waitcnt lgkmcnt(12)
	v_mfma_f32_32x32x16_bf16 v[176:191], a[36:39], v[60:63], v[176:191]
	ds_read_b64_tr_b16 a[8:9], v12 offset:29248
	ds_read_b64_tr_b16 a[10:11], v12 offset:30144
	s_add_u32 m0, s90, 30208
	s_nop 0
	buffer_load_dwordx4 v5, s[92:95], s65 offen lds
	s_waitcnt lgkmcnt(12)
	v_mfma_f32_32x32x16_bf16 v[192:207], a[40:43], v[60:63], v[192:207]
	ds_read_b64_tr_b16 a[12:13], v12 offset:29280
	ds_read_b64_tr_b16 a[14:15], v12 offset:30176
	s_add_u32 m0, s90, 31232
	s_nop 0
	buffer_load_dwordx4 v6, s[92:95], s65 offen lds
	s_waitcnt lgkmcnt(12)
	v_mfma_f32_32x32x16_bf16 v[208:223], a[44:47], v[60:63], v[208:223]
	ds_read_b64_tr_b16 a[16:17], v12 offset:29312
	ds_read_b64_tr_b16 a[18:19], v12 offset:30208
	s_add_u32 m0, s90, 32256
	s_nop 0
	buffer_load_dwordx4 v7, s[92:95], s65 offen lds
	s_waitcnt lgkmcnt(12)
	v_mfma_f32_32x32x16_bf16 v[224:239], a[48:51], v[60:63], v[224:239]
	ds_read_b64_tr_b16 a[20:21], v12 offset:29344
	ds_read_b64_tr_b16 a[22:23], v12 offset:30240
	s_add_u32 m0, s90, 33280
	s_nop 0
	buffer_load_dwordx4 v8, s[92:95], s65 offen lds
	s_waitcnt lgkmcnt(12)
	v_mfma_f32_32x32x16_bf16 v[240:255], a[52:55], v[60:63], v[240:255]
	ds_read_b64_tr_b16 a[24:25], v12 offset:29376
	ds_read_b64_tr_b16 a[26:27], v12 offset:30272
	s_add_u32 m0, s90, 34304
	s_nop 0
	buffer_load_dwordx4 v9, s[92:95], s65 offen lds
	s_waitcnt vmcnt(26)
	s_waitcnt lgkmcnt(12)
	v_mfma_f32_32x32x16_bf16 v[144:159], a[0:3], v[64:67], v[144:159]
	ds_read_b64_tr_b16 a[28:29], v12 offset:30976
	ds_read_b64_tr_b16 a[30:31], v12 offset:31872
	buffer_load_dwordx4 v[120:123], v2, s[44:47], s58 offen offset:2048 sc1
	s_waitcnt lgkmcnt(12)
	v_mfma_f32_32x32x16_bf16 v[160:175], a[4:7], v[64:67], v[160:175]
	ds_read_b64_tr_b16 a[32:33], v12 offset:31008
	ds_read_b64_tr_b16 a[34:35], v12 offset:31904
	s_add_u32 m0, s90, 35328
	s_nop 0
	buffer_load_dwordx4 v10, s[92:95], s65 offen lds
	s_waitcnt lgkmcnt(12)
	v_mfma_f32_32x32x16_bf16 v[176:191], a[8:11], v[64:67], v[176:191]
	ds_read_b64_tr_b16 a[36:37], v12 offset:31040
	ds_read_b64_tr_b16 a[38:39], v12 offset:31936
	s_waitcnt lgkmcnt(12)
	v_mfma_f32_32x32x16_bf16 v[192:207], a[12:15], v[64:67], v[192:207]
	ds_read_b64_tr_b16 a[40:41], v12 offset:31072
	ds_read_b64_tr_b16 a[42:43], v12 offset:31968
	s_waitcnt lgkmcnt(12)
	v_mfma_f32_32x32x16_bf16 v[208:223], a[16:19], v[64:67], v[208:223]
	ds_read_b64_tr_b16 a[44:45], v12 offset:31104
	ds_read_b64_tr_b16 a[46:47], v12 offset:32000
	s_waitcnt lgkmcnt(12)
	v_mfma_f32_32x32x16_bf16 v[224:239], a[20:23], v[64:67], v[224:239]
	ds_read_b64_tr_b16 a[48:49], v12 offset:31136
	ds_read_b64_tr_b16 a[50:51], v12 offset:32032
	s_waitcnt lgkmcnt(12)
	v_mfma_f32_32x32x16_bf16 v[240:255], a[24:27], v[64:67], v[240:255]
	ds_read_b64_tr_b16 a[52:53], v12 offset:31168
	ds_read_b64_tr_b16 a[54:55], v12 offset:32064
	s_waitcnt vmcnt(27)
	s_waitcnt lgkmcnt(12)
	v_mfma_f32_32x32x16_bf16 v[144:159], a[28:31], v[68:71], v[144:159]
	ds_read_b64_tr_b16 a[0:1], v12 offset:43776
	ds_read_b64_tr_b16 a[2:3], v12 offset:44672
	buffer_load_dwordx4 v[124:127], v2, s[44:47], s58 offen offset:3072 sc1
	s_waitcnt lgkmcnt(12)
	v_mfma_f32_32x32x16_bf16 v[160:175], a[32:35], v[68:71], v[160:175]
	ds_read_b64_tr_b16 a[4:5], v12 offset:43808
	ds_read_b64_tr_b16 a[6:7], v12 offset:44704
	s_waitcnt lgkmcnt(12)
	v_mfma_f32_32x32x16_bf16 v[176:191], a[36:39], v[68:71], v[176:191]
	ds_read_b64_tr_b16 a[8:9], v12 offset:43840
	ds_read_b64_tr_b16 a[10:11], v12 offset:44736
	s_waitcnt lgkmcnt(12)
	v_mfma_f32_32x32x16_bf16 v[192:207], a[40:43], v[68:71], v[192:207]
	ds_read_b64_tr_b16 a[12:13], v12 offset:43872
	ds_read_b64_tr_b16 a[14:15], v12 offset:44768
	s_waitcnt lgkmcnt(12)
	v_mfma_f32_32x32x16_bf16 v[208:223], a[44:47], v[68:71], v[208:223]
	ds_read_b64_tr_b16 a[16:17], v12 offset:43904
	ds_read_b64_tr_b16 a[18:19], v12 offset:44800
	s_waitcnt lgkmcnt(12)
	v_mfma_f32_32x32x16_bf16 v[224:239], a[48:51], v[68:71], v[224:239]
	ds_read_b64_tr_b16 a[20:21], v12 offset:43936
	ds_read_b64_tr_b16 a[22:23], v12 offset:44832
	s_waitcnt lgkmcnt(12)
	v_mfma_f32_32x32x16_bf16 v[240:255], a[52:55], v[68:71], v[240:255]
	ds_read_b64_tr_b16 a[24:25], v12 offset:43968
	ds_read_b64_tr_b16 a[26:27], v12 offset:44864
	s_waitcnt vmcnt(27)
	s_waitcnt lgkmcnt(12)
	v_mfma_f32_32x32x16_bf16 v[144:159], a[0:3], v[72:75], v[144:159]
	ds_read_b64_tr_b16 a[28:29], v12 offset:45568
	ds_read_b64_tr_b16 a[30:31], v12 offset:46464
	s_add_u32 s58, s58, 4096
	buffer_load_dwordx4 v[128:131], v2, s[44:47], s58 offen offset:0 sc1
	s_waitcnt lgkmcnt(12)
	v_mfma_f32_32x32x16_bf16 v[160:175], a[4:7], v[72:75], v[160:175]
	ds_read_b64_tr_b16 a[32:33], v12 offset:45600
	ds_read_b64_tr_b16 a[34:35], v12 offset:46496
	s_lshl_b32 s55, s57, 12
	s_add_u32 s55, s55, 524288
	v_and_b32 v14, 31, v1
	v_lshlrev_b32 v14, 3, v14
	v_lshrrev_b32 v15, 5, v1
	v_lshl_add_u32 v14, v15, 11, v14
	v_add_u32 v14, s55, v14
	buffer_load_dwordx2 v[16:17], v14, s[44:47], 0 offen offset:0 sc1
	s_waitcnt lgkmcnt(12)
	v_mfma_f32_32x32x16_bf16 v[176:191], a[8:11], v[72:75], v[176:191]
	ds_read_b64_tr_b16 a[36:37], v12 offset:45632
	ds_read_b64_tr_b16 a[38:39], v12 offset:46528
	buffer_load_dwordx2 v[18:19], v14, s[44:47], 0 offen offset:256 sc1
	s_waitcnt lgkmcnt(12)
	v_mfma_f32_32x32x16_bf16 v[192:207], a[12:15], v[72:75], v[192:207]
	ds_read_b64_tr_b16 a[40:41], v12 offset:45664
	ds_read_b64_tr_b16 a[42:43], v12 offset:46560
	buffer_load_dwordx2 v[20:21], v14, s[44:47], 0 offen offset:512 sc1
	s_waitcnt lgkmcnt(12)
	v_mfma_f32_32x32x16_bf16 v[208:223], a[16:19], v[72:75], v[208:223]
	ds_read_b64_tr_b16 a[44:45], v12 offset:45696
	ds_read_b64_tr_b16 a[46:47], v12 offset:46592
	buffer_load_dwordx2 v[22:23], v14, s[44:47], 0 offen offset:768 sc1
	s_waitcnt lgkmcnt(12)
	v_mfma_f32_32x32x16_bf16 v[224:239], a[20:23], v[72:75], v[224:239]
	ds_read_b64_tr_b16 a[48:49], v12 offset:45728
	ds_read_b64_tr_b16 a[50:51], v12 offset:46624
	buffer_load_dwordx2 v[24:25], v14, s[44:47], 0 offen offset:1024 sc1
	s_waitcnt lgkmcnt(12)
	v_mfma_f32_32x32x16_bf16 v[240:255], a[24:27], v[72:75], v[240:255]
	ds_read_b64_tr_b16 a[52:53], v12 offset:45760
	ds_read_b64_tr_b16 a[54:55], v12 offset:46656
	buffer_load_dwordx2 v[26:27], v14, s[44:47], 0 offen offset:1280 sc1
	s_barrier
	s_waitcnt vmcnt(33)
	s_waitcnt lgkmcnt(12)
	v_mfma_f32_32x32x16_bf16 v[144:159], a[28:31], v[76:79], v[144:159]
	ds_read_b64_tr_b16 a[0:1], v13 offset:0
	ds_read_b64_tr_b16 a[2:3], v13 offset:896
	buffer_load_dwordx4 v[132:135], v2, s[44:47], s58 offen offset:1024 sc1
	s_waitcnt lgkmcnt(12)
	v_mfma_f32_32x32x16_bf16 v[160:175], a[32:35], v[76:79], v[160:175]
	ds_read_b64_tr_b16 a[4:5], v13 offset:32
	ds_read_b64_tr_b16 a[6:7], v13 offset:928
	buffer_load_dwordx2 v[28:29], v14, s[44:47], 0 offen offset:1536 sc1
	s_waitcnt lgkmcnt(12)
	v_mfma_f32_32x32x16_bf16 v[176:191], a[36:39], v[76:79], v[176:191]
	ds_read_b64_tr_b16 a[8:9], v13 offset:64
	ds_read_b64_tr_b16 a[10:11], v13 offset:960
	buffer_load_dwordx2 v[30:31], v14, s[44:47], 0 offen offset:1792 sc1
	s_waitcnt lgkmcnt(12)
	v_mfma_f32_32x32x16_bf16 v[192:207], a[40:43], v[76:79], v[192:207]
	ds_read_b64_tr_b16 a[12:13], v13 offset:96
	ds_read_b64_tr_b16 a[14:15], v13 offset:992
	s_add_u32 m0, s90, 58368
	s_add_u32 s65, s91, 1605632
	buffer_load_dwordx4 v4, s[92:95], s65 offen lds
	s_waitcnt lgkmcnt(12)
	v_mfma_f32_32x32x16_bf16 v[208:223], a[44:47], v[76:79], v[208:223]
	ds_read_b64_tr_b16 a[16:17], v13 offset:128
	ds_read_b64_tr_b16 a[18:19], v13 offset:1024
	s_add_u32 m0, s90, 59392
	s_nop 0
	buffer_load_dwordx4 v5, s[92:95], s65 offen lds
	s_waitcnt lgkmcnt(12)
	v_mfma_f32_32x32x16_bf16 v[224:239], a[48:51], v[76:79], v[224:239]
	ds_read_b64_tr_b16 a[20:21], v13 offset:160
	ds_read_b64_tr_b16 a[22:23], v13 offset:1056
	s_add_u32 m0, s90, 60416
	s_nop 0
	buffer_load_dwordx4 v6, s[92:95], s65 offen lds
	s_waitcnt lgkmcnt(12)
	v_mfma_f32_32x32x16_bf16 v[240:255], a[52:55], v[76:79], v[240:255]
	ds_read_b64_tr_b16 a[24:25], v13 offset:192
	ds_read_b64_tr_b16 a[26:27], v13 offset:1088
	s_add_u32 m0, s90, 61440
	s_nop 0
	buffer_load_dwordx4 v7, s[92:95], s65 offen lds
	s_waitcnt vmcnt(39)
	s_waitcnt lgkmcnt(12)
	v_mfma_f32_32x32x16_bf16 v[144:159], a[0:3], v[80:83], v[144:159]
	ds_read_b64_tr_b16 a[28:29], v13 offset:1792
	ds_read_b64_tr_b16 a[30:31], v13 offset:2688
	buffer_load_dwordx4 v[136:139], v2, s[44:47], s58 offen offset:2048 sc1
	s_waitcnt lgkmcnt(12)
	v_mfma_f32_32x32x16_bf16 v[160:175], a[4:7], v[80:83], v[160:175]
	ds_read_b64_tr_b16 a[32:33], v13 offset:1824
	ds_read_b64_tr_b16 a[34:35], v13 offset:2720
	s_add_u32 m0, s90, 62464
	s_nop 0
	buffer_load_dwordx4 v8, s[92:95], s65 offen lds
	s_waitcnt lgkmcnt(12)
	v_mfma_f32_32x32x16_bf16 v[176:191], a[8:11], v[80:83], v[176:191]
	ds_read_b64_tr_b16 a[36:37], v13 offset:1856
	ds_read_b64_tr_b16 a[38:39], v13 offset:2752
	s_add_u32 m0, s90, 63488
	s_nop 0
	buffer_load_dwordx4 v9, s[92:95], s65 offen lds
	s_waitcnt lgkmcnt(12)
	v_mfma_f32_32x32x16_bf16 v[192:207], a[12:15], v[80:83], v[192:207]
	ds_read_b64_tr_b16 a[40:41], v13 offset:1888
	ds_read_b64_tr_b16 a[42:43], v13 offset:2784
	s_add_u32 m0, s90, 64512
	s_nop 0
	buffer_load_dwordx4 v10, s[92:95], s65 offen lds
	s_waitcnt lgkmcnt(12)
	v_mfma_f32_32x32x16_bf16 v[208:223], a[16:19], v[80:83], v[208:223]
	ds_read_b64_tr_b16 a[44:45], v13 offset:1920
	ds_read_b64_tr_b16 a[46:47], v13 offset:2816
	s_waitcnt lgkmcnt(12)
	v_mfma_f32_32x32x16_bf16 v[224:239], a[20:23], v[80:83], v[224:239]
	ds_read_b64_tr_b16 a[48:49], v13 offset:1952
	ds_read_b64_tr_b16 a[50:51], v13 offset:2848
	s_waitcnt lgkmcnt(12)
	v_mfma_f32_32x32x16_bf16 v[240:255], a[24:27], v[80:83], v[240:255]
	ds_read_b64_tr_b16 a[52:53], v13 offset:1984
	ds_read_b64_tr_b16 a[54:55], v13 offset:2880
	s_waitcnt vmcnt(42)
	s_waitcnt lgkmcnt(12)
	v_mfma_f32_32x32x16_bf16 v[144:159], a[28:31], v[84:87], v[144:159]
	ds_read_b64_tr_b16 a[0:1], v13 offset:14592
	ds_read_b64_tr_b16 a[2:3], v13 offset:15488
	buffer_load_dwordx4 v[140:143], v2, s[44:47], s58 offen offset:3072 sc1
	s_waitcnt lgkmcnt(12)
	v_mfma_f32_32x32x16_bf16 v[160:175], a[32:35], v[84:87], v[160:175]
	ds_read_b64_tr_b16 a[4:5], v13 offset:14624
	ds_read_b64_tr_b16 a[6:7], v13 offset:15520
	s_waitcnt lgkmcnt(12)
	v_mfma_f32_32x32x16_bf16 v[176:191], a[36:39], v[84:87], v[176:191]
	ds_read_b64_tr_b16 a[8:9], v13 offset:14656
	ds_read_b64_tr_b16 a[10:11], v13 offset:15552
	s_waitcnt lgkmcnt(12)
	v_mfma_f32_32x32x16_bf16 v[192:207], a[40:43], v[84:87], v[192:207]
	ds_read_b64_tr_b16 a[12:13], v13 offset:14688
	ds_read_b64_tr_b16 a[14:15], v13 offset:15584
	s_waitcnt lgkmcnt(12)
	v_mfma_f32_32x32x16_bf16 v[208:223], a[44:47], v[84:87], v[208:223]
	ds_read_b64_tr_b16 a[16:17], v13 offset:14720
	ds_read_b64_tr_b16 a[18:19], v13 offset:15616
	s_waitcnt lgkmcnt(12)
	v_mfma_f32_32x32x16_bf16 v[224:239], a[48:51], v[84:87], v[224:239]
	ds_read_b64_tr_b16 a[20:21], v13 offset:14752
	ds_read_b64_tr_b16 a[22:23], v13 offset:15648
	s_waitcnt lgkmcnt(12)
	v_mfma_f32_32x32x16_bf16 v[240:255], a[52:55], v[84:87], v[240:255]
	ds_read_b64_tr_b16 a[24:25], v13 offset:14784
	ds_read_b64_tr_b16 a[26:27], v13 offset:15680
	s_waitcnt vmcnt(42)
	s_waitcnt lgkmcnt(12)
	v_mfma_f32_32x32x16_bf16 v[144:159], a[0:3], v[88:91], v[144:159]
	ds_read_b64_tr_b16 a[28:29], v13 offset:16384
	ds_read_b64_tr_b16 a[30:31], v13 offset:17280
	v_bfe_u32 v14, v1, 2, 1
	v_lshlrev_b32 v14, 3, v14
	v_bfe_u32 v15, v1, 3, 1
	v_lshl_add_u32 v14, v15, 2, v14
	v_and_b32 v15, 3, v1
	v_add_u32 v14, v14, v15
	v_bfe_u32 v15, v1, 4, 1
	v_mul_u32_u24 v15, 1792, v15
	v_add_u32 v14, v14, v15
	s_mul_i32 s55, s51, 112
	v_add_u32 v14, s55, v14
	v_lshlrev_b32 v14, 4, v14
	v_add_u32 v14, 262144, v14
	v_add_u32 v15, 57344, v14
	buffer_load_dwordx4 v[32:35], v14, s[44:47], 0 offen offset:0 sc1
	s_waitcnt lgkmcnt(12)
	v_mfma_f32_32x32x16_bf16 v[160:175], a[4:7], v[88:91], v[160:175]
	ds_read_b64_tr_b16 a[32:33], v13 offset:16416
	ds_read_b64_tr_b16 a[34:35], v13 offset:17312
	buffer_load_dwordx4 v[36:39], v14, s[44:47], 0 offen offset:256 sc1
	s_waitcnt lgkmcnt(12)
	v_mfma_f32_32x32x16_bf16 v[176:191], a[8:11], v[88:91], v[176:191]
	ds_read_b64_tr_b16 a[36:37], v13 offset:16448
	ds_read_b64_tr_b16 a[38:39], v13 offset:17344
	buffer_load_dwordx4 v[40:43], v14, s[44:47], 0 offen offset:512 sc1
	s_waitcnt lgkmcnt(12)
	v_mfma_f32_32x32x16_bf16 v[192:207], a[12:15], v[88:91], v[192:207]
	ds_read_b64_tr_b16 a[40:41], v13 offset:16480
	ds_read_b64_tr_b16 a[42:43], v13 offset:17376
	buffer_load_dwordx4 v[44:47], v14, s[44:47], 0 offen offset:768 sc1
	s_waitcnt lgkmcnt(12)
	v_mfma_f32_32x32x16_bf16 v[208:223], a[16:19], v[88:91], v[208:223]
	ds_read_b64_tr_b16 a[44:45], v13 offset:16512
	ds_read_b64_tr_b16 a[46:47], v13 offset:17408
	buffer_load_dwordx4 v[48:51], v14, s[44:47], 0 offen offset:1024 sc1
	s_waitcnt lgkmcnt(12)
	v_mfma_f32_32x32x16_bf16 v[224:239], a[20:23], v[88:91], v[224:239]
	ds_read_b64_tr_b16 a[48:49], v13 offset:16544
	ds_read_b64_tr_b16 a[50:51], v13 offset:17440
	buffer_load_dwordx4 v[52:55], v14, s[44:47], 0 offen offset:1280 sc1
	s_waitcnt lgkmcnt(12)
	v_mfma_f32_32x32x16_bf16 v[240:255], a[24:27], v[88:91], v[240:255]
	ds_read_b64_tr_b16 a[52:53], v13 offset:16576
	ds_read_b64_tr_b16 a[54:55], v13 offset:17472
	buffer_load_dwordx4 v[56:59], v14, s[44:47], 0 offen offset:1536 sc1
	s_waitcnt vmcnt(38)
	s_barrier
	s_waitcnt lgkmcnt(12)
	v_mfma_f32_32x32x16_bf16 v[144:159], a[28:31], v[92:95], v[144:159]
	ds_read_b64_tr_b16 a[0:1], v11 offset:0
	ds_read_b64_tr_b16 a[2:3], v11 offset:896
	buffer_load_dwordx4 v[60:63], v15, s[44:47], 0 offen offset:0 sc1
	s_waitcnt lgkmcnt(12)
	v_mfma_f32_32x32x16_bf16 v[160:175], a[32:35], v[92:95], v[160:175]
	ds_read_b64_tr_b16 a[4:5], v11 offset:32
	ds_read_b64_tr_b16 a[6:7], v11 offset:928
	buffer_load_dwordx4 v[64:67], v15, s[44:47], 0 offen offset:256 sc1
	s_waitcnt lgkmcnt(12)
	v_mfma_f32_32x32x16_bf16 v[176:191], a[36:39], v[92:95], v[176:191]
	ds_read_b64_tr_b16 a[8:9], v11 offset:64
	ds_read_b64_tr_b16 a[10:11], v11 offset:960
	buffer_load_dwordx4 v[68:71], v15, s[44:47], 0 offen offset:512 sc1
	s_waitcnt lgkmcnt(12)
	v_mfma_f32_32x32x16_bf16 v[192:207], a[40:43], v[92:95], v[192:207]
	ds_read_b64_tr_b16 a[12:13], v11 offset:96
	ds_read_b64_tr_b16 a[14:15], v11 offset:992
	buffer_load_dwordx4 v[72:75], v15, s[44:47], 0 offen offset:768 sc1
	s_waitcnt lgkmcnt(12)
	v_mfma_f32_32x32x16_bf16 v[208:223], a[44:47], v[92:95], v[208:223]
	ds_read_b64_tr_b16 a[16:17], v11 offset:128
	ds_read_b64_tr_b16 a[18:19], v11 offset:1024
	buffer_load_dwordx4 v[76:79], v15, s[44:47], 0 offen offset:1024 sc1
	s_waitcnt lgkmcnt(12)
	v_mfma_f32_32x32x16_bf16 v[224:239], a[48:51], v[92:95], v[224:239]
	ds_read_b64_tr_b16 a[20:21], v11 offset:160
	ds_read_b64_tr_b16 a[22:23], v11 offset:1056
	buffer_load_dwordx4 v[80:83], v15, s[44:47], 0 offen offset:1280 sc1
	s_waitcnt lgkmcnt(12)
	v_mfma_f32_32x32x16_bf16 v[240:255], a[52:55], v[92:95], v[240:255]
	ds_read_b64_tr_b16 a[24:25], v11 offset:192
	ds_read_b64_tr_b16 a[26:27], v11 offset:1088
	buffer_load_dwordx4 v[84:87], v15, s[44:47], 0 offen offset:1536 sc1
	s_waitcnt lgkmcnt(12)
	v_mfma_f32_32x32x16_bf16 v[144:159], a[0:3], v[96:99], v[144:159]
	ds_read_b64_tr_b16 a[28:29], v11 offset:1792
	ds_read_b64_tr_b16 a[30:31], v11 offset:2688
	s_lshl_b32 s55, s49, 2
	s_add_u32 s55, s55, s52
	s_mul_i32 s55, s55, 14336
	v_min_u32 v7, 55, v1
	v_lshlrev_b32 v7, 7, v7
	buffer_load_dword v0, v7, s[28:31], s55 offen
	s_waitcnt lgkmcnt(12)
	v_mfma_f32_32x32x16_bf16 v[160:175], a[4:7], v[96:99], v[160:175]
	ds_read_b64_tr_b16 a[32:33], v11 offset:1824
	ds_read_b64_tr_b16 a[34:35], v11 offset:2720
	s_add_u32 s55, s55, 7168
	buffer_load_dword v0, v7, s[28:31], s55 offen
	s_waitcnt lgkmcnt(12)
	v_mfma_f32_32x32x16_bf16 v[176:191], a[8:11], v[96:99], v[176:191]
	ds_read_b64_tr_b16 a[36:37], v11 offset:1856
	ds_read_b64_tr_b16 a[38:39], v11 offset:2752
	s_waitcnt lgkmcnt(12)
	v_mfma_f32_32x32x16_bf16 v[192:207], a[12:15], v[96:99], v[192:207]
	ds_read_b64_tr_b16 a[40:41], v11 offset:1888
	ds_read_b64_tr_b16 a[42:43], v11 offset:2784
	s_waitcnt lgkmcnt(12)
	v_mfma_f32_32x32x16_bf16 v[208:223], a[16:19], v[96:99], v[208:223]
	ds_read_b64_tr_b16 a[44:45], v11 offset:1920
	ds_read_b64_tr_b16 a[46:47], v11 offset:2816
	s_waitcnt lgkmcnt(12)
	v_mfma_f32_32x32x16_bf16 v[224:239], a[20:23], v[96:99], v[224:239]
	ds_read_b64_tr_b16 a[48:49], v11 offset:1952
	ds_read_b64_tr_b16 a[50:51], v11 offset:2848
	s_waitcnt lgkmcnt(12)
	v_mfma_f32_32x32x16_bf16 v[240:255], a[24:27], v[96:99], v[240:255]
	ds_read_b64_tr_b16 a[52:53], v11 offset:1984
	ds_read_b64_tr_b16 a[54:55], v11 offset:2880
	s_waitcnt lgkmcnt(12)
	v_mfma_f32_32x32x16_bf16 v[144:159], a[28:31], v[100:103], v[144:159]
	ds_read_b64_tr_b16 a[0:1], v11 offset:14592
	ds_read_b64_tr_b16 a[2:3], v11 offset:15488
	s_waitcnt vmcnt(25)
	s_waitcnt lgkmcnt(12)
	v_mfma_f32_32x32x16_bf16 v[160:175], a[32:35], v[100:103], v[160:175]
	ds_read_b64_tr_b16 a[4:5], v11 offset:14624
	ds_read_b64_tr_b16 a[6:7], v11 offset:15520
	v_add_f32 v16, v16, v18
	s_waitcnt lgkmcnt(12)
	v_mfma_f32_32x32x16_bf16 v[176:191], a[36:39], v[100:103], v[176:191]
	ds_read_b64_tr_b16 a[8:9], v11 offset:14656
	ds_read_b64_tr_b16 a[10:11], v11 offset:15552
	v_add_f32 v17, v17, v19
	s_waitcnt lgkmcnt(12)
	v_mfma_f32_32x32x16_bf16 v[192:207], a[40:43], v[100:103], v[192:207]
	ds_read_b64_tr_b16 a[12:13], v11 offset:14688
	ds_read_b64_tr_b16 a[14:15], v11 offset:15584
	v_add_f32 v16, v16, v20
	s_waitcnt lgkmcnt(12)
	v_mfma_f32_32x32x16_bf16 v[208:223], a[44:47], v[100:103], v[208:223]
	ds_read_b64_tr_b16 a[16:17], v11 offset:14720
	ds_read_b64_tr_b16 a[18:19], v11 offset:15616
	v_add_f32 v17, v17, v21
	s_waitcnt lgkmcnt(12)
	v_mfma_f32_32x32x16_bf16 v[224:239], a[48:51], v[100:103], v[224:239]
	ds_read_b64_tr_b16 a[20:21], v11 offset:14752
	ds_read_b64_tr_b16 a[22:23], v11 offset:15648
	v_add_f32 v16, v16, v22
	s_waitcnt lgkmcnt(12)
	v_mfma_f32_32x32x16_bf16 v[240:255], a[52:55], v[100:103], v[240:255]
	ds_read_b64_tr_b16 a[24:25], v11 offset:14784
	ds_read_b64_tr_b16 a[26:27], v11 offset:15680
	v_add_f32 v17, v17, v23
	s_waitcnt lgkmcnt(12)
	v_mfma_f32_32x32x16_bf16 v[144:159], a[0:3], v[104:107], v[144:159]
	ds_read_b64_tr_b16 a[28:29], v11 offset:16384
	ds_read_b64_tr_b16 a[30:31], v11 offset:17280
	v_add_f32 v16, v16, v24
	s_and_b32 s55, s71, 7
	s_lshl_b32 s55, s55, 7
	v_lshrrev_b32 v4, 3, v1
	v_lshlrev_b32 v4, 10, v4
	v_and_b32 v5, 7, v1
	v_bfe_u32 v6, v1, 4, 1
	v_lshlrev_b32 v6, 2, v6
	v_xor_b32 v5, v5, v6
	v_lshl_add_u32 v4, v5, 4, v4
	v_add_u32 v4, s55, v4
	s_mul_i32 s90, s52, 20480
	s_mul_i32 s12, s52, 18432
	s_add_u32 s12, s12, 87552
	s_mul_i32 s3, s52, 458752
	s_waitcnt lgkmcnt(12)
	v_mfma_f32_32x32x16_bf16 v[160:175], a[4:7], v[104:107], v[160:175]
	ds_read_b64_tr_b16 a[32:33], v11 offset:16416
	ds_read_b64_tr_b16 a[34:35], v11 offset:17312
	v_add_f32 v17, v17, v25
	s_waitcnt lgkmcnt(12)
	v_mfma_f32_32x32x16_bf16 v[176:191], a[8:11], v[104:107], v[176:191]
	ds_read_b64_tr_b16 a[36:37], v11 offset:16448
	ds_read_b64_tr_b16 a[38:39], v11 offset:17344
	v_add_f32 v16, v16, v26
	s_waitcnt lgkmcnt(12)
	v_mfma_f32_32x32x16_bf16 v[192:207], a[12:15], v[104:107], v[192:207]
	ds_read_b64_tr_b16 a[40:41], v11 offset:16480
	ds_read_b64_tr_b16 a[42:43], v11 offset:17376
	v_add_f32 v17, v17, v27
	s_waitcnt lgkmcnt(12)
	v_mfma_f32_32x32x16_bf16 v[208:223], a[16:19], v[104:107], v[208:223]
	ds_read_b64_tr_b16 a[44:45], v11 offset:16512
	ds_read_b64_tr_b16 a[46:47], v11 offset:17408
	v_add_f32 v16, v16, v28
	s_waitcnt lgkmcnt(12)
	v_mfma_f32_32x32x16_bf16 v[224:239], a[20:23], v[104:107], v[224:239]
	ds_read_b64_tr_b16 a[48:49], v11 offset:16544
	ds_read_b64_tr_b16 a[50:51], v11 offset:17440
	v_add_f32 v17, v17, v29
	s_waitcnt lgkmcnt(12)
	v_mfma_f32_32x32x16_bf16 v[240:255], a[24:27], v[104:107], v[240:255]
	ds_read_b64_tr_b16 a[52:53], v11 offset:16576
	ds_read_b64_tr_b16 a[54:55], v11 offset:17472
	v_add_f32 v16, v16, v30
	s_barrier
	s_waitcnt lgkmcnt(12)
	v_mfma_f32_32x32x16_bf16 v[144:159], a[28:31], v[108:111], v[144:159]
	ds_read_b64_tr_b16 a[0:1], v11 offset:29184
	ds_read_b64_tr_b16 a[2:3], v11 offset:30080
	v_add_f32 v17, v17, v31
	s_waitcnt lgkmcnt(12)
	v_mfma_f32_32x32x16_bf16 v[160:175], a[32:35], v[108:111], v[160:175]
	ds_read_b64_tr_b16 a[4:5], v11 offset:29216
	ds_read_b64_tr_b16 a[6:7], v11 offset:30112
	v_mov_b32 v18, v16
	s_waitcnt lgkmcnt(12)
	v_mfma_f32_32x32x16_bf16 v[176:191], a[36:39], v[108:111], v[176:191]
	ds_read_b64_tr_b16 a[8:9], v11 offset:29248
	ds_read_b64_tr_b16 a[10:11], v11 offset:30144
	s_nop 1
	s_waitcnt lgkmcnt(12)
	v_mfma_f32_32x32x16_bf16 v[192:207], a[40:43], v[108:111], v[192:207]
	ds_read_b64_tr_b16 a[12:13], v11 offset:29280
	ds_read_b64_tr_b16 a[14:15], v11 offset:30176
	v_permlane32_swap_b32 v16, v18
	s_waitcnt lgkmcnt(12)
	v_mfma_f32_32x32x16_bf16 v[208:223], a[44:47], v[108:111], v[208:223]
	ds_read_b64_tr_b16 a[16:17], v11 offset:29312
	ds_read_b64_tr_b16 a[18:19], v11 offset:30208
	v_add_f32 v16, v16, v18
	s_waitcnt lgkmcnt(12)
	v_mfma_f32_32x32x16_bf16 v[224:239], a[48:51], v[108:111], v[224:239]
	ds_read_b64_tr_b16 a[20:21], v11 offset:29344
	ds_read_b64_tr_b16 a[22:23], v11 offset:30240
	v_mov_b32 v18, v17
	s_waitcnt lgkmcnt(12)
	v_mfma_f32_32x32x16_bf16 v[240:255], a[52:55], v[108:111], v[240:255]
	ds_read_b64_tr_b16 a[24:25], v11 offset:29376
	ds_read_b64_tr_b16 a[26:27], v11 offset:30272
	s_nop 1
	s_waitcnt lgkmcnt(12)
	v_mfma_f32_32x32x16_bf16 v[144:159], a[0:3], v[112:115], v[144:159]
	ds_read_b64_tr_b16 a[28:29], v11 offset:30976
	ds_read_b64_tr_b16 a[30:31], v11 offset:31872
	v_permlane32_swap_b32 v17, v18
	s_waitcnt lgkmcnt(12)
	v_mfma_f32_32x32x16_bf16 v[160:175], a[4:7], v[112:115], v[160:175]
	ds_read_b64_tr_b16 a[32:33], v11 offset:31008
	ds_read_b64_tr_b16 a[34:35], v11 offset:31904
	v_add_f32 v17, v17, v18
	s_waitcnt lgkmcnt(12)
	v_mfma_f32_32x32x16_bf16 v[176:191], a[8:11], v[112:115], v[176:191]
	ds_read_b64_tr_b16 a[36:37], v11 offset:31040
	ds_read_b64_tr_b16 a[38:39], v11 offset:31936
	v_mul_f32 v16, 0x3b000000, v16
	s_waitcnt lgkmcnt(12)
	v_mfma_f32_32x32x16_bf16 v[192:207], a[12:15], v[112:115], v[192:207]
	ds_read_b64_tr_b16 a[40:41], v11 offset:31072
	ds_read_b64_tr_b16 a[42:43], v11 offset:31968
	v_mul_f32 v17, 0x3b000000, v17
	s_waitcnt lgkmcnt(12)
	v_mfma_f32_32x32x16_bf16 v[208:223], a[16:19], v[112:115], v[208:223]
	ds_read_b64_tr_b16 a[44:45], v11 offset:31104
	ds_read_b64_tr_b16 a[46:47], v11 offset:32000
	v_fma_f32 v17, -v16, v16, v17
	s_waitcnt lgkmcnt(12)
	v_mfma_f32_32x32x16_bf16 v[224:239], a[20:23], v[112:115], v[224:239]
	ds_read_b64_tr_b16 a[48:49], v11 offset:31136
	ds_read_b64_tr_b16 a[50:51], v11 offset:32032
	v_max_f32 v17, 0, v17
	s_waitcnt lgkmcnt(12)
	v_mfma_f32_32x32x16_bf16 v[240:255], a[24:27], v[112:115], v[240:255]
	ds_read_b64_tr_b16 a[52:53], v11 offset:31168
	ds_read_b64_tr_b16 a[54:55], v11 offset:32064
	v_add_f32 v17, 0x3727c5ac, v17
	s_waitcnt lgkmcnt(12)
	v_mfma_f32_32x32x16_bf16 v[144:159], a[28:31], v[116:119], v[144:159]
	ds_read_b64_tr_b16 a[0:1], v11 offset:43776
	ds_read_b64_tr_b16 a[2:3], v11 offset:44672
	v_rsq_f32 v18, v17
	s_waitcnt lgkmcnt(12)
	v_mfma_f32_32x32x16_bf16 v[160:175], a[32:35], v[116:119], v[160:175]
	ds_read_b64_tr_b16 a[4:5], v11 offset:43808
	ds_read_b64_tr_b16 a[6:7], v11 offset:44704
	v_sub_f32 v16, 0, v16
	s_waitcnt lgkmcnt(12)
	v_mfma_f32_32x32x16_bf16 v[176:191], a[36:39], v[116:119], v[176:191]
	ds_read_b64_tr_b16 a[8:9], v11 offset:43840
	ds_read_b64_tr_b16 a[10:11], v11 offset:44736
	v_mul_f32 v19, v17, v18
	s_waitcnt lgkmcnt(12)
	v_mfma_f32_32x32x16_bf16 v[192:207], a[40:43], v[116:119], v[192:207]
	ds_read_b64_tr_b16 a[12:13], v11 offset:43872
	ds_read_b64_tr_b16 a[14:15], v11 offset:44768
	v_mul_f32 v20, v18, v18
	s_waitcnt lgkmcnt(12)
	v_mfma_f32_32x32x16_bf16 v[208:223], a[44:47], v[116:119], v[208:223]
	ds_read_b64_tr_b16 a[16:17], v11 offset:43904
	ds_read_b64_tr_b16 a[18:19], v11 offset:44800
	v_cvt_pk_bf16_f32 v22, v16, v19
	s_waitcnt lgkmcnt(12)
	v_mfma_f32_32x32x16_bf16 v[224:239], a[48:51], v[116:119], v[224:239]
	ds_read_b64_tr_b16 a[20:21], v11 offset:43936
	ds_read_b64_tr_b16 a[22:23], v11 offset:44832
	v_lshlrev_b32 v24, 16, v22
	s_waitcnt lgkmcnt(12)
	v_mfma_f32_32x32x16_bf16 v[240:255], a[52:55], v[116:119], v[240:255]
	ds_read_b64_tr_b16 a[24:25], v11 offset:43968
	ds_read_b64_tr_b16 a[26:27], v11 offset:44864
	v_and_b32 v25, s54, v22
	s_waitcnt lgkmcnt(12)
	v_mfma_f32_32x32x16_bf16 v[144:159], a[0:3], v[120:123], v[144:159]
	ds_read_b64_tr_b16 a[28:29], v11 offset:45568
	ds_read_b64_tr_b16 a[30:31], v11 offset:46464
	v_sub_f32 v24, v16, v24
	s_waitcnt lgkmcnt(12)
	v_mfma_f32_32x32x16_bf16 v[160:175], a[4:7], v[120:123], v[160:175]
	ds_read_b64_tr_b16 a[32:33], v11 offset:45600
	ds_read_b64_tr_b16 a[34:35], v11 offset:46496
	v_sub_f32 v25, v19, v25
	s_waitcnt lgkmcnt(12)
	v_mfma_f32_32x32x16_bf16 v[176:191], a[8:11], v[120:123], v[176:191]
	ds_read_b64_tr_b16 a[36:37], v11 offset:45632
	ds_read_b64_tr_b16 a[38:39], v11 offset:46528
	v_cvt_pk_bf16_f32 v23, v24, v25
	s_waitcnt lgkmcnt(12)
	v_mfma_f32_32x32x16_bf16 v[192:207], a[12:15], v[120:123], v[192:207]
	ds_read_b64_tr_b16 a[40:41], v11 offset:45664
	ds_read_b64_tr_b16 a[42:43], v11 offset:46560
	s_mov_b32 s56, 0x01000100
	s_waitcnt lgkmcnt(12)
	v_mfma_f32_32x32x16_bf16 v[208:223], a[16:19], v[120:123], v[208:223]
	ds_read_b64_tr_b16 a[44:45], v11 offset:45696
	ds_read_b64_tr_b16 a[46:47], v11 offset:46592
	v_perm_b32 v28, v22, v22, s56
	s_waitcnt lgkmcnt(12)
	v_mfma_f32_32x32x16_bf16 v[224:239], a[20:23], v[120:123], v[224:239]
	ds_read_b64_tr_b16 a[48:49], v11 offset:45728
	ds_read_b64_tr_b16 a[50:51], v11 offset:46624
	s_mov_b32 s56, 0x07060100
	s_waitcnt lgkmcnt(12)
	v_mfma_f32_32x32x16_bf16 v[240:255], a[24:27], v[120:123], v[240:255]
	ds_read_b64_tr_b16 a[52:53], v11 offset:45760
	ds_read_b64_tr_b16 a[54:55], v11 offset:46656
	v_perm_b32 v29, v22, v23, s56
	s_waitcnt vmcnt(17)
	s_barrier
	s_waitcnt lgkmcnt(12)
	v_mfma_f32_32x32x16_bf16 v[144:159], a[28:31], v[124:127], v[144:159]
	ds_read_b64_tr_b16 a[0:1], v12 offset:0
	ds_read_b64_tr_b16 a[2:3], v12 offset:896
	s_mov_b32 s56, 0x07060302
	s_waitcnt lgkmcnt(12)
	v_mfma_f32_32x32x16_bf16 v[160:175], a[32:35], v[124:127], v[160:175]
	ds_read_b64_tr_b16 a[4:5], v12 offset:32
	ds_read_b64_tr_b16 a[6:7], v12 offset:928
	v_perm_b32 v30, v23, v22, s56
	s_waitcnt lgkmcnt(12)
	v_mfma_f32_32x32x16_bf16 v[176:191], a[36:39], v[124:127], v[176:191]
	ds_read_b64_tr_b16 a[8:9], v12 offset:64
	ds_read_b64_tr_b16 a[10:11], v12 offset:960
	v_mov_b32 v31, 0
	s_waitcnt lgkmcnt(12)
	v_mfma_f32_32x32x16_bf16 v[192:207], a[40:43], v[124:127], v[192:207]
	ds_read_b64_tr_b16 a[12:13], v12 offset:96
	ds_read_b64_tr_b16 a[14:15], v12 offset:992
	v_cmp_gt_u32 vcc, 32, v1
	s_waitcnt lgkmcnt(12)
	v_mfma_f32_32x32x16_bf16 v[208:223], a[44:47], v[124:127], v[208:223]
	ds_read_b64_tr_b16 a[16:17], v12 offset:128
	ds_read_b64_tr_b16 a[18:19], v12 offset:1024
	v_cndmask_b32 v28, 0, v28, vcc
	v_cndmask_b32 v29, 0, v29, vcc
	v_cndmask_b32 v30, 0, v30, vcc
	s_waitcnt lgkmcnt(12)
	v_mfma_f32_32x32x16_bf16 v[224:239], a[48:51], v[124:127], v[224:239]
	ds_read_b64_tr_b16 a[20:21], v12 offset:160
	ds_read_b64_tr_b16 a[22:23], v12 offset:1056
	s_mov_b32 s64, 200000
	s_waitcnt vmcnt(2)
	s_branch L_wext_chk_37
L_wext_loop_36:
	buffer_load_dwordx4 v[32:35], v14, s[44:47], 0 offen offset:0 sc1
	buffer_load_dwordx4 v[36:39], v14, s[44:47], 0 offen offset:256 sc1
	buffer_load_dwordx4 v[40:43], v14, s[44:47], 0 offen offset:512 sc1
	buffer_load_dwordx4 v[44:47], v14, s[44:47], 0 offen offset:768 sc1
	buffer_load_dwordx4 v[48:51], v14, s[44:47], 0 offen offset:1024 sc1
	buffer_load_dwordx4 v[52:55], v14, s[44:47], 0 offen offset:1280 sc1
	buffer_load_dwordx4 v[56:59], v14, s[44:47], 0 offen offset:1536 sc1
	buffer_load_dwordx4 v[60:63], v15, s[44:47], 0 offen offset:0 sc1
	buffer_load_dwordx4 v[64:67], v15, s[44:47], 0 offen offset:256 sc1
	buffer_load_dwordx4 v[68:71], v15, s[44:47], 0 offen offset:512 sc1
	buffer_load_dwordx4 v[72:75], v15, s[44:47], 0 offen offset:768 sc1
	buffer_load_dwordx4 v[76:79], v15, s[44:47], 0 offen offset:1024 sc1
	buffer_load_dwordx4 v[80:83], v15, s[44:47], 0 offen offset:1280 sc1
	buffer_load_dwordx4 v[84:87], v15, s[44:47], 0 offen offset:1536 sc1
	s_waitcnt vmcnt(0)
L_wext_chk_37:
	v_cmp_ne_u32 vcc, s53, v35
	v_cmp_ne_u32 s[68:69], s53, v39
	s_nop 0
	s_or_b64 vcc, vcc, s[68:69]
	v_cmp_ne_u32 s[68:69], s53, v43
	s_nop 0
	s_or_b64 vcc, vcc, s[68:69]
	v_cmp_ne_u32 s[68:69], s53, v47
	s_nop 0
	s_or_b64 vcc, vcc, s[68:69]
	v_cmp_ne_u32 s[68:69], s53, v51
	s_nop 0
	s_or_b64 vcc, vcc, s[68:69]
	v_cmp_ne_u32 s[68:69], s53, v55
	s_nop 0
	s_or_b64 vcc, vcc, s[68:69]
	v_cmp_ne_u32 s[68:69], s53, v59
	s_nop 0
	s_or_b64 vcc, vcc, s[68:69]
	v_cmp_ne_u32 s[68:69], s53, v63
	s_nop 0
	s_or_b64 vcc, vcc, s[68:69]
	v_cmp_ne_u32 s[68:69], s53, v67
	s_nop 0
	s_or_b64 vcc, vcc, s[68:69]
	v_cmp_ne_u32 s[68:69], s53, v71
	s_nop 0
	s_or_b64 vcc, vcc, s[68:69]
	v_cmp_ne_u32 s[68:69], s53, v75
	s_nop 0
	s_or_b64 vcc, vcc, s[68:69]
	v_cmp_ne_u32 s[68:69], s53, v79
	s_nop 0
	s_or_b64 vcc, vcc, s[68:69]
	v_cmp_ne_u32 s[68:69], s53, v83
	s_nop 0
	s_or_b64 vcc, vcc, s[68:69]
	v_cmp_ne_u32 s[68:69], s53, v87
	s_nop 0
	s_or_b64 vcc, vcc, s[68:69]
	s_cbranch_vccz L_wext_ok_38
	s_sub_u32 s64, s64, 1
	s_cmp_lg_u32 s64, 0
	s_cbranch_scc1 L_wext_loop_36
L_wext_ok_38:
	s_waitcnt lgkmcnt(12)
	v_mfma_f32_32x32x16_bf16 v[240:255], a[52:55], v[124:127], v[240:255]
	ds_read_b64_tr_b16 a[24:25], v12 offset:192
	ds_read_b64_tr_b16 a[26:27], v12 offset:1088
	v_mov_b32 v35, 0
	s_waitcnt lgkmcnt(12)
	v_mfma_f32_32x32x16_bf16 v[144:159], a[0:3], v[128:131], v[144:159]
	ds_read_b64_tr_b16 a[28:29], v12 offset:1792
	ds_read_b64_tr_b16 a[30:31], v12 offset:2688
	v_mov_b32 v39, 0
	s_waitcnt lgkmcnt(12)
	v_mfma_f32_32x32x16_bf16 v[160:175], a[4:7], v[128:131], v[160:175]
	ds_read_b64_tr_b16 a[32:33], v12 offset:1824
	ds_read_b64_tr_b16 a[34:35], v12 offset:2720
	v_mov_b32 v43, 0
	s_waitcnt lgkmcnt(12)
	v_mfma_f32_32x32x16_bf16 v[176:191], a[8:11], v[128:131], v[176:191]
	ds_read_b64_tr_b16 a[36:37], v12 offset:1856
	ds_read_b64_tr_b16 a[38:39], v12 offset:2752
	v_mov_b32 v47, 0
	s_waitcnt lgkmcnt(12)
	v_mfma_f32_32x32x16_bf16 v[192:207], a[12:15], v[128:131], v[192:207]
	ds_read_b64_tr_b16 a[40:41], v12 offset:1888
	ds_read_b64_tr_b16 a[42:43], v12 offset:2784
	v_mov_b32 v51, 0
	s_waitcnt lgkmcnt(12)
	v_mfma_f32_32x32x16_bf16 v[208:223], a[16:19], v[128:131], v[208:223]
	ds_read_b64_tr_b16 a[44:45], v12 offset:1920
	ds_read_b64_tr_b16 a[46:47], v12 offset:2816
	v_mov_b32 v55, 0
	s_waitcnt lgkmcnt(12)
	v_mfma_f32_32x32x16_bf16 v[224:239], a[20:23], v[128:131], v[224:239]
	ds_read_b64_tr_b16 a[48:49], v12 offset:1952
	ds_read_b64_tr_b16 a[50:51], v12 offset:2848
	v_mov_b32 v59, 0
	s_waitcnt lgkmcnt(12)
	v_mfma_f32_32x32x16_bf16 v[240:255], a[24:27], v[128:131], v[240:255]
	ds_read_b64_tr_b16 a[52:53], v12 offset:1984
	ds_read_b64_tr_b16 a[54:55], v12 offset:2880
	v_mov_b32 v63, 0
	s_waitcnt lgkmcnt(12)
	v_mfma_f32_32x32x16_bf16 v[144:159], a[28:31], v[132:135], v[144:159]
	ds_read_b64_tr_b16 a[0:1], v12 offset:14592
	ds_read_b64_tr_b16 a[2:3], v12 offset:15488
	v_mov_b32 v67, 0
	s_waitcnt lgkmcnt(12)
	v_mfma_f32_32x32x16_bf16 v[160:175], a[32:35], v[132:135], v[160:175]
	ds_read_b64_tr_b16 a[4:5], v12 offset:14624
	ds_read_b64_tr_b16 a[6:7], v12 offset:15520
	v_mov_b32 v71, 0
	s_waitcnt lgkmcnt(12)
	v_mfma_f32_32x32x16_bf16 v[176:191], a[36:39], v[132:135], v[176:191]
	ds_read_b64_tr_b16 a[8:9], v12 offset:14656
	ds_read_b64_tr_b16 a[10:11], v12 offset:15552
	v_mov_b32 v75, 0
	s_waitcnt lgkmcnt(12)
	v_mfma_f32_32x32x16_bf16 v[192:207], a[40:43], v[132:135], v[192:207]
	ds_read_b64_tr_b16 a[12:13], v12 offset:14688
	ds_read_b64_tr_b16 a[14:15], v12 offset:15584
	v_mov_b32 v79, 0
	s_waitcnt lgkmcnt(12)
	v_mfma_f32_32x32x16_bf16 v[208:223], a[44:47], v[132:135], v[208:223]
	ds_read_b64_tr_b16 a[16:17], v12 offset:14720
	ds_read_b64_tr_b16 a[18:19], v12 offset:15616
	v_mov_b32 v83, 0
	s_waitcnt lgkmcnt(12)
	v_mfma_f32_32x32x16_bf16 v[224:239], a[48:51], v[132:135], v[224:239]
	ds_read_b64_tr_b16 a[20:21], v12 offset:14752
	ds_read_b64_tr_b16 a[22:23], v12 offset:15648
	v_mov_b32 v87, 0
	s_waitcnt lgkmcnt(12)
	v_mfma_f32_32x32x16_bf16 v[240:255], a[52:55], v[132:135], v[240:255]
	ds_read_b64_tr_b16 a[24:25], v12 offset:14784
	ds_read_b64_tr_b16 a[26:27], v12 offset:15680
	s_waitcnt lgkmcnt(12)
	v_mfma_f32_32x32x16_bf16 v[144:159], a[0:3], v[136:139], v[144:159]
	ds_read_b64_tr_b16 a[28:29], v12 offset:16384
	ds_read_b64_tr_b16 a[30:31], v12 offset:17280
	s_waitcnt lgkmcnt(12)
	v_mfma_f32_32x32x16_bf16 v[160:175], a[4:7], v[136:139], v[160:175]
	ds_read_b64_tr_b16 a[32:33], v12 offset:16416
	ds_read_b64_tr_b16 a[34:35], v12 offset:17312
	s_waitcnt lgkmcnt(12)
	v_mfma_f32_32x32x16_bf16 v[176:191], a[8:11], v[136:139], v[176:191]
	ds_read_b64_tr_b16 a[36:37], v12 offset:16448
	ds_read_b64_tr_b16 a[38:39], v12 offset:17344
	s_waitcnt lgkmcnt(12)
	v_mfma_f32_32x32x16_bf16 v[192:207], a[12:15], v[136:139], v[192:207]
	ds_read_b64_tr_b16 a[40:41], v12 offset:16480
	ds_read_b64_tr_b16 a[42:43], v12 offset:17376
	s_waitcnt lgkmcnt(12)
	v_mfma_f32_32x32x16_bf16 v[208:223], a[16:19], v[136:139], v[208:223]
	ds_read_b64_tr_b16 a[44:45], v12 offset:16512
	ds_read_b64_tr_b16 a[46:47], v12 offset:17408
	s_waitcnt lgkmcnt(12)
	v_mfma_f32_32x32x16_bf16 v[224:239], a[20:23], v[136:139], v[224:239]
	ds_read_b64_tr_b16 a[48:49], v12 offset:16544
	ds_read_b64_tr_b16 a[50:51], v12 offset:17440
	s_waitcnt lgkmcnt(12)
	v_mfma_f32_32x32x16_bf16 v[240:255], a[24:27], v[136:139], v[240:255]
	ds_read_b64_tr_b16 a[52:53], v12 offset:16576
	ds_read_b64_tr_b16 a[54:55], v12 offset:17472
	s_waitcnt lgkmcnt(12)
	v_mfma_f32_32x32x16_bf16 v[144:159], a[28:31], v[140:143], v[144:159]
	s_waitcnt lgkmcnt(10)
	v_mfma_f32_32x32x16_bf16 v[160:175], a[32:35], v[140:143], v[160:175]
	s_waitcnt lgkmcnt(8)
	v_mfma_f32_32x32x16_bf16 v[176:191], a[36:39], v[140:143], v[176:191]
	s_waitcnt lgkmcnt(6)
	v_mfma_f32_32x32x16_bf16 v[192:207], a[40:43], v[140:143], v[192:207]
	s_waitcnt lgkmcnt(4)
	v_mfma_f32_32x32x16_bf16 v[208:223], a[44:47], v[140:143], v[208:223]
	s_waitcnt lgkmcnt(2)
	v_mfma_f32_32x32x16_bf16 v[224:239], a[48:51], v[140:143], v[224:239]
	s_waitcnt lgkmcnt(0)
	v_mfma_f32_32x32x16_bf16 v[240:255], a[52:55], v[140:143], v[240:255]
	v_mfma_f32_32x32x16_bf16 v[144:159], v[32:35], v[28:31], v[144:159]
	v_mfma_f32_32x32x16_bf16 v[160:175], v[36:39], v[28:31], v[160:175]
	v_mfma_f32_32x32x16_bf16 v[176:191], v[40:43], v[28:31], v[176:191]
	v_mfma_f32_32x32x16_bf16 v[192:207], v[44:47], v[28:31], v[192:207]
	v_mfma_f32_32x32x16_bf16 v[208:223], v[48:51], v[28:31], v[208:223]
	v_mfma_f32_32x32x16_bf16 v[224:239], v[52:55], v[28:31], v[224:239]
	v_mfma_f32_32x32x16_bf16 v[240:255], v[56:59], v[28:31], v[240:255]
	v_mfma_f32_32x32x16_bf16 v[144:159], v[60:63], v[28:31], v[144:159]
	v_mfma_f32_32x32x16_bf16 v[160:175], v[64:67], v[28:31], v[160:175]
	v_mfma_f32_32x32x16_bf16 v[176:191], v[68:71], v[28:31], v[176:191]
	v_mfma_f32_32x32x16_bf16 v[192:207], v[72:75], v[28:31], v[192:207]
	v_mfma_f32_32x32x16_bf16 v[208:223], v[76:79], v[28:31], v[208:223]
	v_mfma_f32_32x32x16_bf16 v[224:239], v[80:83], v[28:31], v[224:239]
	v_mfma_f32_32x32x16_bf16 v[240:255], v[84:87], v[28:31], v[240:255]
	s_barrier
	v_lshrrev_b32 v8, 5, v1
	v_bfe_u32 v11, v1, 4, 1
	v_bfe_u32 v9, v1, 2, 2
	v_and_b32 v10, 3, v1
	v_and_b32 v13, 1, v10
	v_lshlrev_b32 v13, 5, v13
	v_lshrrev_b32 v14, 1, v10
	v_lshlrev_b32 v14, 3, v14
	v_lshl_add_u32 v12, v11, 4, v13
	v_add_u32 v12, v12, v14
	v_mul_u32_u24 v8, 8, v8
	v_add_u32 v8, v8, v9
	v_lshlrev_b32 v8, 7, v8
	v_lshrrev_b32 v9, 1, v9
	v_lshl_add_u32 v8, v9, 6, v8
	v_add_u32 v5, v8, v12
	v_add_u32 v10, s12, v5
	v_xor_b32 v11, 64, v10
	v_add_u32 v5, s90, v5
	v_xor_b32 v6, 64, v5
	s_mul_i32 s55, s57, 112
	s_mul_i32 s56, s51, 7
	s_add_u32 s55, s55, s56
	s_lshl_b32 s55, s55, 10
	s_add_u32 s91, s55, 8388608
	v_pk_mul_f32 v[152:153], v[152:153], v[20:21] op_sel_hi:[1,0]
	v_pk_mul_f32 v[154:155], v[154:155], v[20:21] op_sel_hi:[1,0]
	v_pk_mul_f32 v[156:157], v[156:157], v[20:21] op_sel_hi:[1,0]
	v_pk_mul_f32 v[158:159], v[158:159], v[20:21] op_sel_hi:[1,0]
	v_max_f32 v144, 0, v144
	v_max_f32 v145, 0, v145
	v_max_f32 v146, 0, v146
	v_max_f32 v147, 0, v147
	v_max_f32 v148, 0, v148
	v_max_f32 v149, 0, v149
	v_max_f32 v150, 0, v150
	v_max_f32 v151, 0, v151
	v_pk_mul_f32 v[144:145], v[144:145], v[152:153]
	v_pk_mul_f32 v[146:147], v[146:147], v[154:155]
	v_pk_mul_f32 v[148:149], v[148:149], v[156:157]
	v_pk_mul_f32 v[150:151], v[150:151], v[158:159]
	v_cvt_pk_bf16_f32 v96, v144, v145
	v_cvt_pk_bf16_f32 v97, v146, v147
	v_cvt_pk_bf16_f32 v98, v148, v149
	v_cvt_pk_bf16_f32 v99, v150, v151
	buffer_store_dwordx4 v[96:99], v2, s[44:47], s91 offen offset:0 sc1
	v_pk_mul_f32 v[168:169], v[168:169], v[20:21] op_sel_hi:[1,0]
	v_pk_mul_f32 v[170:171], v[170:171], v[20:21] op_sel_hi:[1,0]
	v_pk_mul_f32 v[172:173], v[172:173], v[20:21] op_sel_hi:[1,0]
	v_pk_mul_f32 v[174:175], v[174:175], v[20:21] op_sel_hi:[1,0]
	v_max_f32 v160, 0, v160
	v_max_f32 v161, 0, v161
	v_max_f32 v162, 0, v162
	v_max_f32 v163, 0, v163
	v_max_f32 v164, 0, v164
	v_max_f32 v165, 0, v165
	v_max_f32 v166, 0, v166
	v_max_f32 v167, 0, v167
	v_pk_mul_f32 v[160:161], v[160:161], v[168:169]
	v_pk_mul_f32 v[162:163], v[162:163], v[170:171]
	v_pk_mul_f32 v[164:165], v[164:165], v[172:173]
	v_pk_mul_f32 v[166:167], v[166:167], v[174:175]
	v_cvt_pk_bf16_f32 v100, v160, v161
	v_cvt_pk_bf16_f32 v101, v162, v163
	v_cvt_pk_bf16_f32 v102, v164, v165
	v_cvt_pk_bf16_f32 v103, v166, v167
	buffer_store_dwordx4 v[100:103], v2, s[44:47], s91 offen offset:1024 sc1
	v_pk_mul_f32 v[184:185], v[184:185], v[20:21] op_sel_hi:[1,0]
	v_pk_mul_f32 v[186:187], v[186:187], v[20:21] op_sel_hi:[1,0]
	v_pk_mul_f32 v[188:189], v[188:189], v[20:21] op_sel_hi:[1,0]
	v_pk_mul_f32 v[190:191], v[190:191], v[20:21] op_sel_hi:[1,0]
	v_max_f32 v176, 0, v176
	v_max_f32 v177, 0, v177
	v_max_f32 v178, 0, v178
	v_max_f32 v179, 0, v179
	v_max_f32 v180, 0, v180
	v_max_f32 v181, 0, v181
	v_max_f32 v182, 0, v182
	v_max_f32 v183, 0, v183
	v_pk_mul_f32 v[176:177], v[176:177], v[184:185]
	v_pk_mul_f32 v[178:179], v[178:179], v[186:187]
	v_pk_mul_f32 v[180:181], v[180:181], v[188:189]
	v_pk_mul_f32 v[182:183], v[182:183], v[190:191]
	v_cvt_pk_bf16_f32 v104, v176, v177
	v_cvt_pk_bf16_f32 v105, v178, v179
	v_cvt_pk_bf16_f32 v106, v180, v181
	v_cvt_pk_bf16_f32 v107, v182, v183
	buffer_store_dwordx4 v[104:107], v2, s[44:47], s91 offen offset:2048 sc1
	v_pk_mul_f32 v[200:201], v[200:201], v[20:21] op_sel_hi:[1,0]
	v_pk_mul_f32 v[202:203], v[202:203], v[20:21] op_sel_hi:[1,0]
	v_pk_mul_f32 v[204:205], v[204:205], v[20:21] op_sel_hi:[1,0]
	v_pk_mul_f32 v[206:207], v[206:207], v[20:21] op_sel_hi:[1,0]
	v_max_f32 v192, 0, v192
	v_max_f32 v193, 0, v193
	v_max_f32 v194, 0, v194
	v_max_f32 v195, 0, v195
	v_max_f32 v196, 0, v196
	v_max_f32 v197, 0, v197
	v_max_f32 v198, 0, v198
	v_max_f32 v199, 0, v199
	v_pk_mul_f32 v[192:193], v[192:193], v[200:201]
	v_pk_mul_f32 v[194:195], v[194:195], v[202:203]
	v_pk_mul_f32 v[196:197], v[196:197], v[204:205]
	v_pk_mul_f32 v[198:199], v[198:199], v[206:207]
	v_cvt_pk_bf16_f32 v108, v192, v193
	v_cvt_pk_bf16_f32 v109, v194, v195
	v_cvt_pk_bf16_f32 v110, v196, v197
	v_cvt_pk_bf16_f32 v111, v198, v199
	buffer_store_dwordx4 v[108:111], v2, s[44:47], s91 offen offset:3072 sc1
	s_add_u32 s91, s91, 4096
	v_pk_mul_f32 v[216:217], v[216:217], v[20:21] op_sel_hi:[1,0]
	v_pk_mul_f32 v[218:219], v[218:219], v[20:21] op_sel_hi:[1,0]
	v_pk_mul_f32 v[220:221], v[220:221], v[20:21] op_sel_hi:[1,0]
	v_pk_mul_f32 v[222:223], v[222:223], v[20:21] op_sel_hi:[1,0]
	v_max_f32 v208, 0, v208
	v_max_f32 v209, 0, v209
	v_max_f32 v210, 0, v210
	v_max_f32 v211, 0, v211
	v_max_f32 v212, 0, v212
	v_max_f32 v213, 0, v213
	v_max_f32 v214, 0, v214
	v_max_f32 v215, 0, v215
	v_pk_mul_f32 v[208:209], v[208:209], v[216:217]
	v_pk_mul_f32 v[210:211], v[210:211], v[218:219]
	v_pk_mul_f32 v[212:213], v[212:213], v[220:221]
	v_pk_mul_f32 v[214:215], v[214:215], v[222:223]
	v_cvt_pk_bf16_f32 v112, v208, v209
	v_cvt_pk_bf16_f32 v113, v210, v211
	v_cvt_pk_bf16_f32 v114, v212, v213
	v_cvt_pk_bf16_f32 v115, v214, v215
	buffer_store_dwordx4 v[112:115], v2, s[44:47], s91 offen offset:0 sc1
	v_pk_mul_f32 v[232:233], v[232:233], v[20:21] op_sel_hi:[1,0]
	v_pk_mul_f32 v[234:235], v[234:235], v[20:21] op_sel_hi:[1,0]
	v_pk_mul_f32 v[236:237], v[236:237], v[20:21] op_sel_hi:[1,0]
	v_pk_mul_f32 v[238:239], v[238:239], v[20:21] op_sel_hi:[1,0]
	v_max_f32 v224, 0, v224
	v_max_f32 v225, 0, v225
	v_max_f32 v226, 0, v226
	v_max_f32 v227, 0, v227
	v_max_f32 v228, 0, v228
	v_max_f32 v229, 0, v229
	v_max_f32 v230, 0, v230
	v_max_f32 v231, 0, v231
	v_pk_mul_f32 v[224:225], v[224:225], v[232:233]
	v_pk_mul_f32 v[226:227], v[226:227], v[234:235]
	v_pk_mul_f32 v[228:229], v[228:229], v[236:237]
	v_pk_mul_f32 v[230:231], v[230:231], v[238:239]
	v_cvt_pk_bf16_f32 v116, v224, v225
	v_cvt_pk_bf16_f32 v117, v226, v227
	v_cvt_pk_bf16_f32 v118, v228, v229
	v_cvt_pk_bf16_f32 v119, v230, v231
	buffer_store_dwordx4 v[116:119], v2, s[44:47], s91 offen offset:1024 sc1
	v_pk_mul_f32 v[248:249], v[248:249], v[20:21] op_sel_hi:[1,0]
	v_pk_mul_f32 v[250:251], v[250:251], v[20:21] op_sel_hi:[1,0]
	v_pk_mul_f32 v[252:253], v[252:253], v[20:21] op_sel_hi:[1,0]
	v_pk_mul_f32 v[254:255], v[254:255], v[20:21] op_sel_hi:[1,0]
	v_max_f32 v240, 0, v240
	v_max_f32 v241, 0, v241
	v_max_f32 v242, 0, v242
	v_max_f32 v243, 0, v243
	v_max_f32 v244, 0, v244
	v_max_f32 v245, 0, v245
	v_max_f32 v246, 0, v246
	v_max_f32 v247, 0, v247
	v_pk_mul_f32 v[240:241], v[240:241], v[248:249]
	v_pk_mul_f32 v[242:243], v[242:243], v[250:251]
	v_pk_mul_f32 v[244:245], v[244:245], v[252:253]
	v_pk_mul_f32 v[246:247], v[246:247], v[254:255]
	v_cvt_pk_bf16_f32 v120, v240, v241
	v_cvt_pk_bf16_f32 v121, v242, v243
	v_cvt_pk_bf16_f32 v122, v244, v245
	v_cvt_pk_bf16_f32 v123, v246, v247
	buffer_store_dwordx4 v[120:123], v2, s[44:47], s91 offen offset:2048 sc1
	s_add_u32 s65, s3, 0
	s_add_u32 m0, s12, 0
	s_nop 0
	buffer_load_dwordx4 v4, s[28:31], s65 offen lds
	s_add_u32 s65, s3, 8192
	s_add_u32 m0, s12, 1024
	s_nop 0
	buffer_load_dwordx4 v4, s[28:31], s65 offen lds
	s_add_u32 s65, s3, 16384
	s_add_u32 m0, s12, 2048
	s_nop 0
	buffer_load_dwordx4 v4, s[28:31], s65 offen lds
	s_add_u32 s65, s3, 24576
	s_add_u32 m0, s12, 3072
	s_nop 0
	buffer_load_dwordx4 v4, s[28:31], s65 offen lds
	s_add_u32 s65, s3, 32768
	s_add_u32 m0, s12, 4096
	s_nop 0
	buffer_load_dwordx4 v4, s[28:31], s65 offen lds
	s_add_u32 s65, s3, 40960
	s_add_u32 m0, s12, 5120
	s_nop 0
	buffer_load_dwordx4 v4, s[28:31], s65 offen lds
	s_add_u32 s65, s3, 49152
	s_add_u32 m0, s12, 6144
	s_nop 0
	buffer_load_dwordx4 v4, s[28:31], s65 offen lds
	s_add_u32 s65, s3, 57344
	s_add_u32 m0, s12, 7168
	s_nop 0
	buffer_load_dwordx4 v4, s[28:31], s65 offen lds
	s_waitcnt vmcnt(8)
	s_lshl_b32 s55, s50, 4
	s_add_u32 s55, s55, s51
	s_lshl_b32 s55, s55, 7
	s_add_u32 s55, s55, 114688
	s_barrier
	s_cmp_eq_u32 s52, 0
	s_cbranch_scc0 L_fa_sig_39
	v_mov_b32 v14, s55
	s_mov_b64 exec, 1
	buffer_store_dword v3, v14, s[44:47], 0 offen sc1
	s_mov_b64 exec, -1
L_fa_sig_39:
	s_add_u32 s65, s3, 65536
	s_add_u32 m0, s12, 8192
	s_nop 0
	buffer_load_dwordx4 v4, s[28:31], s65 offen lds
	s_add_u32 s65, s3, 73728
	s_add_u32 m0, s12, 9216
	s_nop 0
	buffer_load_dwordx4 v4, s[28:31], s65 offen lds
	s_add_u32 s65, s3, 81920
	s_add_u32 m0, s12, 10240
	s_nop 0
	buffer_load_dwordx4 v4, s[28:31], s65 offen lds
	s_add_u32 s65, s3, 90112
	s_add_u32 m0, s12, 11264
	s_nop 0
	buffer_load_dwordx4 v4, s[28:31], s65 offen lds
	s_add_u32 s65, s3, 98304
	s_add_u32 m0, s12, 12288
	s_nop 0
	buffer_load_dwordx4 v4, s[28:31], s65 offen lds
	s_add_u32 s65, s3, 106496
	s_add_u32 m0, s12, 13312
	s_nop 0
	buffer_load_dwordx4 v4, s[28:31], s65 offen lds
	s_add_u32 s65, s3, 114688
	s_add_u32 m0, s12, 14336
	s_nop 0
	buffer_load_dwordx4 v4, s[28:31], s65 offen lds
	s_add_u32 s65, s3, 122880
	s_add_u32 m0, s12, 15360
	s_nop 0
	buffer_load_dwordx4 v4, s[28:31], s65 offen lds
	s_add_u32 s65, s3, 131072
	s_add_u32 m0, s12, 16384
	s_nop 0
	buffer_load_dwordx4 v4, s[28:31], s65 offen lds
	s_add_u32 s65, s3, 139264
	s_add_u32 m0, s12, 17408
	s_nop 0
	buffer_load_dwordx4 v4, s[28:31], s65 offen lds
	s_add_u32 s65, s3, 147456
	s_add_u32 m0, s90, 0
	s_nop 0
	buffer_load_dwordx4 v4, s[28:31], s65 offen lds
	s_add_u32 s65, s3, 155648
	s_add_u32 m0, s90, 1024
	s_nop 0
	buffer_load_dwordx4 v4, s[28:31], s65 offen lds
	s_add_u32 s65, s3, 163840
	s_add_u32 m0, s90, 2048
	s_nop 0
	buffer_load_dwordx4 v4, s[28:31], s65 offen lds
	s_add_u32 s65, s3, 172032
	s_add_u32 m0, s90, 3072
	s_nop 0
	buffer_load_dwordx4 v4, s[28:31], s65 offen lds
	s_add_u32 s65, s3, 180224
	s_add_u32 m0, s90, 4096
	s_nop 0
	buffer_load_dwordx4 v4, s[28:31], s65 offen lds
	s_add_u32 s65, s3, 188416
	s_add_u32 m0, s90, 5120
	s_nop 0
	buffer_load_dwordx4 v4, s[28:31], s65 offen lds
	s_add_u32 s65, s3, 196608
	s_add_u32 m0, s90, 6144
	s_nop 0
	buffer_load_dwordx4 v4, s[28:31], s65 offen lds
	s_add_u32 s65, s3, 204800
	s_add_u32 m0, s90, 7168
	s_nop 0
	buffer_load_dwordx4 v4, s[28:31], s65 offen lds
	s_add_u32 s65, s3, 212992
	s_add_u32 m0, s90, 8192
	s_nop 0
	buffer_load_dwordx4 v4, s[28:31], s65 offen lds
	s_add_u32 s65, s3, 221184
	s_add_u32 m0, s90, 9216
	s_nop 0
	buffer_load_dwordx4 v4, s[28:31], s65 offen lds
	s_add_u32 s65, s3, 229376
	s_add_u32 m0, s90, 10240
	s_nop 0
	buffer_load_dwordx4 v4, s[28:31], s65 offen lds
	s_add_u32 s65, s3, 237568
	s_add_u32 m0, s90, 11264
	s_nop 0
	buffer_load_dwordx4 v4, s[28:31], s65 offen lds
	s_add_u32 s65, s3, 245760
	s_add_u32 m0, s90, 12288
	s_nop 0
	buffer_load_dwordx4 v4, s[28:31], s65 offen lds
	s_add_u32 s65, s3, 253952
	s_add_u32 m0, s90, 13312
	s_nop 0
	buffer_load_dwordx4 v4, s[28:31], s65 offen lds
	s_add_u32 s65, s3, 262144
	s_add_u32 m0, s90, 14336
	s_nop 0
	buffer_load_dwordx4 v4, s[28:31], s65 offen lds
	s_add_u32 s65, s3, 270336
	s_add_u32 m0, s90, 15360
	s_nop 0
	buffer_load_dwordx4 v4, s[28:31], s65 offen lds
	s_add_u32 s65, s3, 278528
	s_add_u32 m0, s90, 16384
	s_nop 0
	buffer_load_dwordx4 v4, s[28:31], s65 offen lds
	s_add_u32 s65, s3, 286720
	s_add_u32 m0, s90, 17408
	s_nop 0
	buffer_load_dwordx4 v4, s[28:31], s65 offen lds
	s_add_u32 s65, s3, 294912
	s_add_u32 m0, s90, 18432
	s_nop 0
	buffer_load_dwordx4 v4, s[28:31], s65 offen lds
	s_add_u32 s65, s3, 303104
	s_add_u32 m0, s90, 19456
	s_nop 0
	buffer_load_dwordx4 v4, s[28:31], s65 offen lds
	s_waitcnt vmcnt(20)
	ds_read_b64_tr_b16 a[0:1], v10 offset:0
	ds_read_b64_tr_b16 a[2:3], v10 offset:512
	ds_read_b64_tr_b16 a[4:5], v11 offset:0
	ds_read_b64_tr_b16 a[6:7], v11 offset:512
	ds_read_b64_tr_b16 a[8:9], v10 offset:2048
	ds_read_b64_tr_b16 a[10:11], v10 offset:2560
	ds_read_b64_tr_b16 a[12:13], v11 offset:2048
	ds_read_b64_tr_b16 a[14:15], v11 offset:2560
	s_waitcnt lgkmcnt(4)
	ds_read_b64_tr_b16 a[16:17], v10 offset:4096
	ds_read_b64_tr_b16 a[18:19], v10 offset:4608
	ds_read_b64_tr_b16 a[20:21], v11 offset:4096
	ds_read_b64_tr_b16 a[22:23], v11 offset:4608
	ds_read_b64_tr_b16 a[24:25], v10 offset:6144
	ds_read_b64_tr_b16 a[26:27], v10 offset:6656
	ds_read_b64_tr_b16 a[28:29], v11 offset:6144
	ds_read_b64_tr_b16 a[30:31], v11 offset:6656
	s_waitcnt lgkmcnt(4)
	ds_read_b64_tr_b16 a[32:33], v10 offset:8192
	ds_read_b64_tr_b16 a[34:35], v10 offset:8704
	ds_read_b64_tr_b16 a[36:37], v11 offset:8192
	ds_read_b64_tr_b16 a[38:39], v11 offset:8704
	ds_read_b64_tr_b16 a[40:41], v10 offset:10240
	ds_read_b64_tr_b16 a[42:43], v10 offset:10752
	ds_read_b64_tr_b16 a[44:45], v11 offset:10240
	ds_read_b64_tr_b16 a[46:47], v11 offset:10752
	s_waitcnt lgkmcnt(4)
	ds_read_b64_tr_b16 a[48:49], v10 offset:12288
	ds_read_b64_tr_b16 a[50:51], v10 offset:12800
	ds_read_b64_tr_b16 a[52:53], v11 offset:12288
	ds_read_b64_tr_b16 a[54:55], v11 offset:12800
	ds_read_b64_tr_b16 a[56:57], v10 offset:14336
	ds_read_b64_tr_b16 a[58:59], v10 offset:14848
	ds_read_b64_tr_b16 a[60:61], v11 offset:14336
	ds_read_b64_tr_b16 a[62:63], v11 offset:14848
	s_waitcnt lgkmcnt(4)
	ds_read_b64_tr_b16 a[64:65], v10 offset:16384
	ds_read_b64_tr_b16 a[66:67], v10 offset:16896
	ds_read_b64_tr_b16 a[68:69], v11 offset:16384
	ds_read_b64_tr_b16 a[70:71], v11 offset:16896
	s_waitcnt lgkmcnt(0)
	v_lshrrev_b32 v8, 5, v1
	v_lshlrev_b32 v8, 6, v8
	s_lshl_b32 s55, s99, 7
	s_add_u32 s55, s55, 14336
	v_add_u32 v8, s55, v8
	s_lshl_b32 s55, s70, 11
	s_add_u32 s55, s55, 114688
	s_add_u32 s65, s3, 311296
	s_add_u32 m0, s12, 0
	s_nop 0
	buffer_load_dwordx4 v4, s[28:31], s65 offen lds
	s_add_u32 s65, s3, 319488
	s_add_u32 m0, s12, 1024
	s_nop 0
	buffer_load_dwordx4 v4, s[28:31], s65 offen lds
	s_add_u32 s65, s3, 327680
	s_add_u32 m0, s12, 2048
	s_nop 0
	buffer_load_dwordx4 v4, s[28:31], s65 offen lds
	s_add_u32 s65, s3, 335872
	s_add_u32 m0, s12, 3072
	s_nop 0
	buffer_load_dwordx4 v4, s[28:31], s65 offen lds
	s_add_u32 s65, s3, 344064
	s_add_u32 m0, s12, 4096
	s_nop 0
	buffer_load_dwordx4 v4, s[28:31], s65 offen lds
	s_add_u32 s65, s3, 352256
	s_add_u32 m0, s12, 5120
	s_nop 0
	buffer_load_dwordx4 v4, s[28:31], s65 offen lds
	s_add_u32 s65, s3, 360448
	s_add_u32 m0, s12, 6144
	s_nop 0
	buffer_load_dwordx4 v4, s[28:31], s65 offen lds
	s_add_u32 s65, s3, 368640
	s_add_u32 m0, s12, 7168
	s_nop 0
	buffer_load_dwordx4 v4, s[28:31], s65 offen lds
	s_add_u32 s65, s3, 376832
	s_add_u32 m0, s12, 8192
	s_nop 0
	buffer_load_dwordx4 v4, s[28:31], s65 offen lds
	s_add_u32 s65, s3, 385024
	s_add_u32 m0, s12, 9216
	s_nop 0
	buffer_load_dwordx4 v4, s[28:31], s65 offen lds
	s_add_u32 s65, s3, 393216
	s_add_u32 m0, s12, 10240
	s_nop 0
	buffer_load_dwordx4 v4, s[28:31], s65 offen lds
	s_add_u32 s65, s3, 401408
	s_add_u32 m0, s12, 11264
	s_nop 0
	buffer_load_dwordx4 v4, s[28:31], s65 offen lds
	s_add_u32 s65, s3, 409600
	s_add_u32 m0, s12, 12288
	s_nop 0
	buffer_load_dwordx4 v4, s[28:31], s65 offen lds
	s_add_u32 s65, s3, 417792
	s_add_u32 m0, s12, 13312
	s_nop 0
	buffer_load_dwordx4 v4, s[28:31], s65 offen lds
	s_add_u32 s65, s3, 425984
	s_add_u32 m0, s12, 14336
	s_nop 0
	buffer_load_dwordx4 v4, s[28:31], s65 offen lds
	s_add_u32 s65, s3, 434176
	s_add_u32 m0, s12, 15360
	s_nop 0
	buffer_load_dwordx4 v4, s[28:31], s65 offen lds
	s_add_u32 s65, s3, 442368
	s_add_u32 m0, s12, 16384
	s_nop 0
	buffer_load_dwordx4 v4, s[28:31], s65 offen lds
	s_add_u32 s65, s3, 450560
	s_add_u32 m0, s12, 17408
	s_nop 0
	buffer_load_dwordx4 v4, s[28:31], s65 offen lds
	s_cmp_eq_u32 s52, 0
	s_cbranch_scc0 L_pa_skip_40
	v_min_u32 v14, 15, v1
	v_lshlrev_b32 v14, 7, v14
	v_add_u32 v14, s55, v14
	s_mov_b32 s64, 200000
L_pa_loop_41:
	buffer_load_dword v15, v14, s[44:47], 0 offen sc1
	s_waitcnt vmcnt(0)
	v_cmp_ne_u32 vcc, s53, v15
	s_cbranch_vccz L_pa_ok_42
	s_sub_u32 s64, s64, 1
	s_cmp_lg_u32 s64, 0
	s_cbranch_scc1 L_pa_loop_41
L_pa_ok_42:
L_pa_skip_40:
	s_barrier
	s_sub_u32 s55, s98, s96
	s_mul_i32 s55, s55, 114688
	s_mul_i32 s56, s52, 28672
	s_add_u32 s55, s55, s56
	s_add_u32 s58, s55, 8388608
	s_add_u32 s59, s58, 114688
	buffer_load_dwordx4 v[16:19], v2, s[44:47], s58 offen offset:0 sc1
	buffer_load_dwordx4 v[20:23], v2, s[44:47], s59 offen offset:0 sc1
	buffer_load_dwordx4 v[24:27], v2, s[44:47], s58 offen offset:1024 sc1
	buffer_load_dwordx4 v[28:31], v2, s[44:47], s59 offen offset:1024 sc1
	buffer_load_dwordx4 v[32:35], v2, s[44:47], s58 offen offset:2048 sc1
	buffer_load_dwordx4 v[36:39], v2, s[44:47], s59 offen offset:2048 sc1
	buffer_load_dwordx4 v[40:43], v2, s[44:47], s58 offen offset:3072 sc1
	buffer_load_dwordx4 v[44:47], v2, s[44:47], s59 offen offset:3072 sc1
	s_add_u32 s58, s58, 4096
	s_add_u32 s59, s59, 4096
	buffer_load_dwordx4 v[48:51], v2, s[44:47], s58 offen offset:0 sc1
	buffer_load_dwordx4 v[52:55], v2, s[44:47], s59 offen offset:0 sc1
	buffer_load_dwordx4 v[56:59], v2, s[44:47], s58 offen offset:1024 sc1
	buffer_load_dwordx4 v[60:63], v2, s[44:47], s59 offen offset:1024 sc1
	buffer_load_dwordx4 v[64:67], v2, s[44:47], s58 offen offset:2048 sc1
	buffer_load_dwordx4 v[68:71], v2, s[44:47], s59 offen offset:2048 sc1
	buffer_load_dwordx4 v[176:179], v8, s[44:47], 0 offen offset:0 sc1
	buffer_load_dwordx4 v[180:183], v8, s[44:47], 0 offen offset:16 sc1
	buffer_load_dwordx4 v[184:187], v8, s[44:47], 0 offen offset:32 sc1
	buffer_load_dwordx4 v[188:191], v8, s[44:47], 0 offen offset:48 sc1
	s_waitcnt vmcnt(16)
	v_mfma_f32_32x32x16_bf16 v[192:207], a[0:3], v[16:19], 0
	v_mfma_f32_32x32x16_bf16 v[224:239], a[4:7], v[16:19], 0
	v_mfma_f32_32x32x16_bf16 v[208:223], a[0:3], v[20:23], 0
	buffer_load_dwordx4 v[16:19], v2, s[44:47], s58 offen offset:3072 sc1
	v_mfma_f32_32x32x16_bf16 v[240:255], a[4:7], v[20:23], 0
	buffer_load_dwordx4 v[20:23], v2, s[44:47], s59 offen offset:3072 sc1
	s_add_u32 s58, s58, 4096
	s_add_u32 s59, s59, 4096
	s_waitcnt vmcnt(16)
	v_mfma_f32_32x32x16_bf16 v[192:207], a[8:11], v[24:27], v[192:207]
	v_mfma_f32_32x32x16_bf16 v[224:239], a[12:15], v[24:27], v[224:239]
	v_mfma_f32_32x32x16_bf16 v[208:223], a[8:11], v[28:31], v[208:223]
	buffer_load_dwordx4 v[24:27], v2, s[44:47], s58 offen offset:0 sc1
	v_mfma_f32_32x32x16_bf16 v[240:255], a[12:15], v[28:31], v[240:255]
	buffer_load_dwordx4 v[28:31], v2, s[44:47], s59 offen offset:0 sc1
	s_waitcnt vmcnt(16)
	v_mfma_f32_32x32x16_bf16 v[192:207], a[16:19], v[32:35], v[192:207]
	v_mfma_f32_32x32x16_bf16 v[224:239], a[20:23], v[32:35], v[224:239]
	v_mfma_f32_32x32x16_bf16 v[208:223], a[16:19], v[36:39], v[208:223]
	buffer_load_dwordx4 v[32:35], v2, s[44:47], s58 offen offset:1024 sc1
	v_mfma_f32_32x32x16_bf16 v[240:255], a[20:23], v[36:39], v[240:255]
	buffer_load_dwordx4 v[36:39], v2, s[44:47], s59 offen offset:1024 sc1
	s_waitcnt vmcnt(16)
	v_mfma_f32_32x32x16_bf16 v[192:207], a[24:27], v[40:43], v[192:207]
	v_mfma_f32_32x32x16_bf16 v[224:239], a[28:31], v[40:43], v[224:239]
	v_mfma_f32_32x32x16_bf16 v[208:223], a[24:27], v[44:47], v[208:223]
	buffer_load_dwordx4 v[40:43], v2, s[44:47], s58 offen offset:2048 sc1
	v_mfma_f32_32x32x16_bf16 v[240:255], a[28:31], v[44:47], v[240:255]
	buffer_load_dwordx4 v[44:47], v2, s[44:47], s59 offen offset:2048 sc1
	s_waitcnt vmcnt(16)
	v_mfma_f32_32x32x16_bf16 v[192:207], a[32:35], v[48:51], v[192:207]
	v_mfma_f32_32x32x16_bf16 v[224:239], a[36:39], v[48:51], v[224:239]
	v_mfma_f32_32x32x16_bf16 v[208:223], a[32:35], v[52:55], v[208:223]
	buffer_load_dwordx4 v[48:51], v2, s[44:47], s58 offen offset:3072 sc1
	v_mfma_f32_32x32x16_bf16 v[240:255], a[36:39], v[52:55], v[240:255]
	buffer_load_dwordx4 v[52:55], v2, s[44:47], s59 offen offset:3072 sc1
	s_add_u32 s58, s58, 4096
	s_add_u32 s59, s59, 4096
	s_waitcnt vmcnt(16)
	v_mfma_f32_32x32x16_bf16 v[192:207], a[40:43], v[56:59], v[192:207]
	v_mfma_f32_32x32x16_bf16 v[224:239], a[44:47], v[56:59], v[224:239]
	v_mfma_f32_32x32x16_bf16 v[208:223], a[40:43], v[60:63], v[208:223]
	buffer_load_dwordx4 v[56:59], v2, s[44:47], s58 offen offset:0 sc1
	v_mfma_f32_32x32x16_bf16 v[240:255], a[44:47], v[60:63], v[240:255]
	buffer_load_dwordx4 v[60:63], v2, s[44:47], s59 offen offset:0 sc1
	s_waitcnt vmcnt(16)
	v_mfma_f32_32x32x16_bf16 v[192:207], a[48:51], v[64:67], v[192:207]
	ds_read_b64_tr_b16 a[72:73], v5 offset:0
	v_mfma_f32_32x32x16_bf16 v[224:239], a[52:55], v[64:67], v[224:239]
	ds_read_b64_tr_b16 a[74:75], v5 offset:512
	v_mfma_f32_32x32x16_bf16 v[208:223], a[48:51], v[68:71], v[208:223]
	ds_read_b64_tr_b16 a[76:77], v6 offset:0
	buffer_load_dwordx4 v[64:67], v2, s[44:47], s58 offen offset:1024 sc1
	v_mfma_f32_32x32x16_bf16 v[240:255], a[52:55], v[68:71], v[240:255]
	ds_read_b64_tr_b16 a[78:79], v6 offset:512
	buffer_load_dwordx4 v[68:71], v2, s[44:47], s59 offen offset:1024 sc1
	s_waitcnt vmcnt(12)
	v_mfma_f32_32x32x16_bf16 v[192:207], a[56:59], v[16:19], v[192:207]
	ds_read_b64_tr_b16 a[80:81], v5 offset:2048
	v_mfma_f32_32x32x16_bf16 v[224:239], a[60:63], v[16:19], v[224:239]
	ds_read_b64_tr_b16 a[82:83], v5 offset:2560
	v_mfma_f32_32x32x16_bf16 v[208:223], a[56:59], v[20:23], v[208:223]
	ds_read_b64_tr_b16 a[84:85], v6 offset:2048
	buffer_load_dwordx4 v[16:19], v2, s[44:47], s58 offen offset:2048 sc1
	v_mfma_f32_32x32x16_bf16 v[240:255], a[60:63], v[20:23], v[240:255]
	ds_read_b64_tr_b16 a[86:87], v6 offset:2560
	buffer_load_dwordx4 v[20:23], v2, s[44:47], s59 offen offset:2048 sc1
	s_waitcnt vmcnt(12)
	v_mfma_f32_32x32x16_bf16 v[192:207], a[64:67], v[24:27], v[192:207]
	ds_read_b64_tr_b16 a[88:89], v5 offset:4096
	v_mfma_f32_32x32x16_bf16 v[224:239], a[68:71], v[24:27], v[224:239]
	ds_read_b64_tr_b16 a[90:91], v5 offset:4608
	v_mfma_f32_32x32x16_bf16 v[208:223], a[64:67], v[28:31], v[208:223]
	ds_read_b64_tr_b16 a[92:93], v6 offset:4096
	buffer_load_dwordx4 v[24:27], v2, s[44:47], s58 offen offset:3072 sc1
	v_mfma_f32_32x32x16_bf16 v[240:255], a[68:71], v[28:31], v[240:255]
	ds_read_b64_tr_b16 a[94:95], v6 offset:4608
	buffer_load_dwordx4 v[28:31], v2, s[44:47], s59 offen offset:3072 sc1
	s_add_u32 s58, s58, 4096
	s_add_u32 s59, s59, 4096
	s_waitcnt vmcnt(12)
	s_waitcnt lgkmcnt(8)
	v_mfma_f32_32x32x16_bf16 v[192:207], a[72:75], v[32:35], v[192:207]
	ds_read_b64_tr_b16 a[96:97], v5 offset:6144
	v_mfma_f32_32x32x16_bf16 v[224:239], a[76:79], v[32:35], v[224:239]
	ds_read_b64_tr_b16 a[98:99], v5 offset:6656
	v_mfma_f32_32x32x16_bf16 v[208:223], a[72:75], v[36:39], v[208:223]
	ds_read_b64_tr_b16 a[100:101], v6 offset:6144
	buffer_load_dwordx4 v[32:35], v2, s[44:47], s58 offen offset:0 sc1
	v_mfma_f32_32x32x16_bf16 v[240:255], a[76:79], v[36:39], v[240:255]
	ds_read_b64_tr_b16 a[102:103], v6 offset:6656
	buffer_load_dwordx4 v[36:39], v2, s[44:47], s59 offen offset:0 sc1
	s_waitcnt vmcnt(12)
	s_waitcnt lgkmcnt(8)
	v_mfma_f32_32x32x16_bf16 v[192:207], a[80:83], v[40:43], v[192:207]
	ds_read_b64_tr_b16 a[104:105], v5 offset:8192
	s_mov_b32 s64, 200000
	s_branch L_gb_chk_44
L_gb_loop_43:
	buffer_load_dwordx4 v[176:179], v8, s[44:47], 0 offen offset:0 sc1
	buffer_load_dwordx4 v[180:183], v8, s[44:47], 0 offen offset:16 sc1
	buffer_load_dwordx4 v[184:187], v8, s[44:47], 0 offen offset:32 sc1
	buffer_load_dwordx4 v[188:191], v8, s[44:47], 0 offen offset:48 sc1
	s_waitcnt vmcnt(0)
L_gb_chk_44:
	v_cmp_ne_u32 vcc, s53, v177
	v_cmp_ne_u32 s[68:69], s53, v179
	s_nop 0
	s_or_b64 vcc, vcc, s[68:69]
	v_cmp_ne_u32 s[68:69], s53, v181
	s_nop 0
	s_or_b64 vcc, vcc, s[68:69]
	v_cmp_ne_u32 s[68:69], s53, v183
	s_nop 0
	s_or_b64 vcc, vcc, s[68:69]
	v_cmp_ne_u32 s[68:69], s53, v185
	s_nop 0
	s_or_b64 vcc, vcc, s[68:69]
	v_cmp_ne_u32 s[68:69], s53, v187
	s_nop 0
	s_or_b64 vcc, vcc, s[68:69]
	v_cmp_ne_u32 s[68:69], s53, v189
	s_nop 0
	s_or_b64 vcc, vcc, s[68:69]
	v_cmp_ne_u32 s[68:69], s53, v191
	s_nop 0
	s_or_b64 vcc, vcc, s[68:69]
	s_cbranch_vccz L_gb_ok_45
	s_sub_u32 s64, s64, 1
	s_cmp_lg_u32 s64, 0
	s_cbranch_scc1 L_gb_loop_43
L_gb_ok_45:
	v_mfma_f32_32x32x16_bf16 v[224:239], a[84:87], v[40:43], v[224:239]
	ds_read_b64_tr_b16 a[106:107], v5 offset:8704
	v_lshlrev_b32 v112, 16, v176
	v_mfma_f32_32x32x16_bf16 v[208:223], a[80:83], v[44:47], v[208:223]
	ds_read_b64_tr_b16 a[108:109], v6 offset:8192
	buffer_load_dwordx4 v[40:43], v2, s[44:47], s58 offen offset:1024 sc1
	v_and_b32 v113, s54, v176
	v_mfma_f32_32x32x16_bf16 v[240:255], a[84:87], v[44:47], v[240:255]
	ds_read_b64_tr_b16 a[110:111], v6 offset:8704
	buffer_load_dwordx4 v[44:47], v2, s[44:47], s59 offen offset:1024 sc1
	v_accvgpr_read_b32 v144, a248
	s_waitcnt vmcnt(12)
	s_waitcnt lgkmcnt(8)
	v_mfma_f32_32x32x16_bf16 v[192:207], a[88:91], v[48:51], v[192:207]
	ds_read_b64_tr_b16 a[112:113], v5 offset:10240
	v_lshlrev_b32 v128, 16, v144
	v_mfma_f32_32x32x16_bf16 v[224:239], a[92:95], v[48:51], v[224:239]
	ds_read_b64_tr_b16 a[114:115], v5 offset:10752
	v_and_b32 v129, s54, v144
	v_mfma_f32_32x32x16_bf16 v[208:223], a[88:91], v[52:55], v[208:223]
	ds_read_b64_tr_b16 a[116:117], v6 offset:10240
	buffer_load_dwordx4 v[48:51], v2, s[44:47], s58 offen offset:2048 sc1
	v_lshlrev_b32 v114, 16, v178
	v_mfma_f32_32x32x16_bf16 v[240:255], a[92:95], v[52:55], v[240:255]
	ds_read_b64_tr_b16 a[118:119], v6 offset:10752
	buffer_load_dwordx4 v[52:55], v2, s[44:47], s59 offen offset:2048 sc1
	v_and_b32 v115, s54, v178
	s_waitcnt vmcnt(12)
	s_waitcnt lgkmcnt(8)
	v_mfma_f32_32x32x16_bf16 v[192:207], a[96:99], v[56:59], v[192:207]
	ds_read_b64_tr_b16 a[120:121], v5 offset:12288
	v_accvgpr_read_b32 v144, a249
	v_mfma_f32_32x32x16_bf16 v[224:239], a[100:103], v[56:59], v[224:239]
	ds_read_b64_tr_b16 a[122:123], v5 offset:12800
	v_lshlrev_b32 v130, 16, v144
	v_mfma_f32_32x32x16_bf16 v[208:223], a[96:99], v[60:63], v[208:223]
	ds_read_b64_tr_b16 a[124:125], v6 offset:12288
	buffer_load_dwordx4 v[56:59], v2, s[44:47], s58 offen offset:3072 sc1
	v_and_b32 v131, s54, v144
	v_mfma_f32_32x32x16_bf16 v[240:255], a[100:103], v[60:63], v[240:255]
	ds_read_b64_tr_b16 a[126:127], v6 offset:12800
	buffer_load_dwordx4 v[60:63], v2, s[44:47], s59 offen offset:3072 sc1
	v_lshlrev_b32 v116, 16, v180
	s_add_u32 s58, s58, 4096
	s_add_u32 s59, s59, 4096
	s_waitcnt vmcnt(12)
	s_waitcnt lgkmcnt(8)
	v_mfma_f32_32x32x16_bf16 v[192:207], a[104:107], v[64:67], v[192:207]
	ds_read_b64_tr_b16 a[128:129], v5 offset:14336
	v_and_b32 v117, s54, v180
	v_mfma_f32_32x32x16_bf16 v[224:239], a[108:111], v[64:67], v[224:239]
	ds_read_b64_tr_b16 a[130:131], v5 offset:14848
	v_accvgpr_read_b32 v144, a250
	v_mfma_f32_32x32x16_bf16 v[208:223], a[104:107], v[68:71], v[208:223]
	ds_read_b64_tr_b16 a[132:133], v6 offset:14336
	buffer_load_dwordx4 v[64:67], v2, s[44:47], s58 offen offset:0 sc1
	v_lshlrev_b32 v132, 16, v144
	v_mfma_f32_32x32x16_bf16 v[240:255], a[108:111], v[68:71], v[240:255]
	ds_read_b64_tr_b16 a[134:135], v6 offset:14848
	buffer_load_dwordx4 v[68:71], v2, s[44:47], s59 offen offset:0 sc1
	v_and_b32 v133, s54, v144
	s_waitcnt vmcnt(12)
	s_waitcnt lgkmcnt(8)
	v_mfma_f32_32x32x16_bf16 v[192:207], a[112:115], v[16:19], v[192:207]
	ds_read_b64_tr_b16 a[136:137], v5 offset:16384
	v_lshlrev_b32 v118, 16, v182
	v_mfma_f32_32x32x16_bf16 v[224:239], a[116:119], v[16:19], v[224:239]
	ds_read_b64_tr_b16 a[138:139], v5 offset:16896
	v_and_b32 v119, s54, v182
	v_mfma_f32_32x32x16_bf16 v[208:223], a[112:115], v[20:23], v[208:223]
	ds_read_b64_tr_b16 a[140:141], v6 offset:16384
	buffer_load_dwordx4 v[16:19], v2, s[44:47], s58 offen offset:1024 sc1
	v_accvgpr_read_b32 v144, a251
	v_mfma_f32_32x32x16_bf16 v[240:255], a[116:119], v[20:23], v[240:255]
	ds_read_b64_tr_b16 a[142:143], v6 offset:16896
	buffer_load_dwordx4 v[20:23], v2, s[44:47], s59 offen offset:1024 sc1
	v_lshlrev_b32 v134, 16, v144
	s_waitcnt vmcnt(12)
	s_waitcnt lgkmcnt(8)
	v_mfma_f32_32x32x16_bf16 v[192:207], a[120:123], v[24:27], v[192:207]
	ds_read_b64_tr_b16 a[144:145], v5 offset:18432
	v_and_b32 v135, s54, v144
	v_mfma_f32_32x32x16_bf16 v[224:239], a[124:127], v[24:27], v[224:239]
	ds_read_b64_tr_b16 a[146:147], v5 offset:18944
	v_lshlrev_b32 v120, 16, v184
	v_mfma_f32_32x32x16_bf16 v[208:223], a[120:123], v[28:31], v[208:223]
	ds_read_b64_tr_b16 a[148:149], v6 offset:18432
	buffer_load_dwordx4 v[24:27], v2, s[44:47], s58 offen offset:2048 sc1
	v_and_b32 v121, s54, v184
	v_mfma_f32_32x32x16_bf16 v[240:255], a[124:127], v[28:31], v[240:255]
	ds_read_b64_tr_b16 a[150:151], v6 offset:18944
	buffer_load_dwordx4 v[28:31], v2, s[44:47], s59 offen offset:2048 sc1
	v_accvgpr_read_b32 v144, a252
	s_waitcnt vmcnt(12)
	s_waitcnt lgkmcnt(8)
	v_mfma_f32_32x32x16_bf16 v[192:207], a[128:131], v[32:35], v[192:207]
	ds_read_b64_tr_b16 a[152:153], v10 offset:0
	v_lshlrev_b32 v136, 16, v144
	v_mfma_f32_32x32x16_bf16 v[224:239], a[132:135], v[32:35], v[224:239]
	ds_read_b64_tr_b16 a[154:155], v10 offset:512
	v_and_b32 v137, s54, v144
	v_mfma_f32_32x32x16_bf16 v[208:223], a[128:131], v[36:39], v[208:223]
	ds_read_b64_tr_b16 a[156:157], v11 offset:0
	buffer_load_dwordx4 v[32:35], v2, s[44:47], s58 offen offset:3072 sc1
	v_lshlrev_b32 v122, 16, v186
	v_mfma_f32_32x32x16_bf16 v[240:255], a[132:135], v[36:39], v[240:255]
	ds_read_b64_tr_b16 a[158:159], v11 offset:512
	buffer_load_dwordx4 v[36:39], v2, s[44:47], s59 offen offset:3072 sc1
	v_and_b32 v123, s54, v186
	s_add_u32 s58, s58, 4096
	s_add_u32 s59, s59, 4096
	s_waitcnt vmcnt(12)
	s_waitcnt lgkmcnt(8)
	v_mfma_f32_32x32x16_bf16 v[192:207], a[136:139], v[40:43], v[192:207]
	ds_read_b64_tr_b16 a[160:161], v10 offset:2048
	v_accvgpr_read_b32 v144, a253
	v_mfma_f32_32x32x16_bf16 v[224:239], a[140:143], v[40:43], v[224:239]
	ds_read_b64_tr_b16 a[162:163], v10 offset:2560
	v_lshlrev_b32 v138, 16, v144
	v_mfma_f32_32x32x16_bf16 v[208:223], a[136:139], v[44:47], v[208:223]
	ds_read_b64_tr_b16 a[164:165], v11 offset:2048
	buffer_load_dwordx4 v[40:43], v2, s[44:47], s58 offen offset:0 sc1
	v_and_b32 v139, s54, v144
	v_mfma_f32_32x32x16_bf16 v[240:255], a[140:143], v[44:47], v[240:255]
	ds_read_b64_tr_b16 a[166:167], v11 offset:2560
	buffer_load_dwordx4 v[44:47], v2, s[44:47], s59 offen offset:0 sc1
	v_lshlrev_b32 v124, 16, v188
	s_waitcnt vmcnt(12)
	s_waitcnt lgkmcnt(8)
	v_mfma_f32_32x32x16_bf16 v[192:207], a[144:147], v[48:51], v[192:207]
	ds_read_b64_tr_b16 a[168:169], v10 offset:4096
	v_and_b32 v125, s54, v188
	v_mfma_f32_32x32x16_bf16 v[224:239], a[148:151], v[48:51], v[224:239]
	ds_read_b64_tr_b16 a[170:171], v10 offset:4608
	v_accvgpr_read_b32 v144, a254
	v_mfma_f32_32x32x16_bf16 v[208:223], a[144:147], v[52:55], v[208:223]
	ds_read_b64_tr_b16 a[172:173], v11 offset:4096
	buffer_load_dwordx4 v[48:51], v2, s[44:47], s58 offen offset:1024 sc1
	v_lshlrev_b32 v140, 16, v144
	v_mfma_f32_32x32x16_bf16 v[240:255], a[148:151], v[52:55], v[240:255]
	ds_read_b64_tr_b16 a[174:175], v11 offset:4608
	buffer_load_dwordx4 v[52:55], v2, s[44:47], s59 offen offset:1024 sc1
	v_and_b32 v141, s54, v144
	s_waitcnt vmcnt(12)
	s_waitcnt lgkmcnt(8)
	v_mfma_f32_32x32x16_bf16 v[192:207], a[152:155], v[56:59], v[192:207]
	ds_read_b64_tr_b16 a[176:177], v10 offset:6144
	v_lshlrev_b32 v126, 16, v190
	v_mfma_f32_32x32x16_bf16 v[224:239], a[156:159], v[56:59], v[224:239]
	ds_read_b64_tr_b16 a[178:179], v10 offset:6656
	v_and_b32 v127, s54, v190
	v_mfma_f32_32x32x16_bf16 v[208:223], a[152:155], v[60:63], v[208:223]
	ds_read_b64_tr_b16 a[180:181], v11 offset:6144
	buffer_load_dwordx4 v[56:59], v2, s[44:47], s58 offen offset:2048 sc1
	v_accvgpr_read_b32 v144, a255
	v_mfma_f32_32x32x16_bf16 v[240:255], a[156:159], v[60:63], v[240:255]
	ds_read_b64_tr_b16 a[182:183], v11 offset:6656
	buffer_load_dwordx4 v[60:63], v2, s[44:47], s59 offen offset:2048 sc1
	v_lshlrev_b32 v142, 16, v144
	s_waitcnt vmcnt(12)
	s_waitcnt lgkmcnt(8)
	v_mfma_f32_32x32x16_bf16 v[192:207], a[160:163], v[64:67], v[192:207]
	ds_read_b64_tr_b16 a[184:185], v10 offset:8192
	v_and_b32 v143, s54, v144
	v_mfma_f32_32x32x16_bf16 v[224:239], a[164:167], v[64:67], v[224:239]
	ds_read_b64_tr_b16 a[186:187], v10 offset:8704
	v_mfma_f32_32x32x16_bf16 v[208:223], a[160:163], v[68:71], v[208:223]
	ds_read_b64_tr_b16 a[188:189], v11 offset:8192
	buffer_load_dwordx4 v[64:67], v2, s[44:47], s58 offen offset:3072 sc1
	v_mfma_f32_32x32x16_bf16 v[240:255], a[164:167], v[68:71], v[240:255]
	ds_read_b64_tr_b16 a[190:191], v11 offset:8704
	buffer_load_dwordx4 v[68:71], v2, s[44:47], s59 offen offset:3072 sc1
	s_add_u32 s58, s58, 4096
	s_add_u32 s59, s59, 4096
	s_waitcnt vmcnt(12)
	s_waitcnt lgkmcnt(8)
	v_mfma_f32_32x32x16_bf16 v[192:207], a[168:171], v[16:19], v[192:207]
	ds_read_b64_tr_b16 a[192:193], v10 offset:10240
	v_mfma_f32_32x32x16_bf16 v[224:239], a[172:175], v[16:19], v[224:239]
	ds_read_b64_tr_b16 a[194:195], v10 offset:10752
	v_mfma_f32_32x32x16_bf16 v[208:223], a[168:171], v[20:23], v[208:223]
	ds_read_b64_tr_b16 a[196:197], v11 offset:10240
	v_mfma_f32_32x32x16_bf16 v[240:255], a[172:175], v[20:23], v[240:255]
	ds_read_b64_tr_b16 a[198:199], v11 offset:10752
	s_waitcnt vmcnt(10)
	s_waitcnt lgkmcnt(8)
	v_mfma_f32_32x32x16_bf16 v[192:207], a[176:179], v[24:27], v[192:207]
	ds_read_b64_tr_b16 a[200:201], v10 offset:12288
	v_mfma_f32_32x32x16_bf16 v[224:239], a[180:183], v[24:27], v[224:239]
	ds_read_b64_tr_b16 a[202:203], v10 offset:12800
	v_mfma_f32_32x32x16_bf16 v[208:223], a[176:179], v[28:31], v[208:223]
	ds_read_b64_tr_b16 a[204:205], v11 offset:12288
	v_mfma_f32_32x32x16_bf16 v[240:255], a[180:183], v[28:31], v[240:255]
	ds_read_b64_tr_b16 a[206:207], v11 offset:12800
	s_waitcnt vmcnt(8)
	s_waitcnt lgkmcnt(8)
	v_mfma_f32_32x32x16_bf16 v[192:207], a[184:187], v[32:35], v[192:207]
	ds_read_b64_tr_b16 a[208:209], v10 offset:14336
	v_mfma_f32_32x32x16_bf16 v[224:239], a[188:191], v[32:35], v[224:239]
	ds_read_b64_tr_b16 a[210:211], v10 offset:14848
	v_mfma_f32_32x32x16_bf16 v[208:223], a[184:187], v[36:39], v[208:223]
	ds_read_b64_tr_b16 a[212:213], v11 offset:14336
	v_mfma_f32_32x32x16_bf16 v[240:255], a[188:191], v[36:39], v[240:255]
	ds_read_b64_tr_b16 a[214:215], v11 offset:14848
	s_waitcnt vmcnt(6)
	s_waitcnt lgkmcnt(8)
	v_mfma_f32_32x32x16_bf16 v[192:207], a[192:195], v[40:43], v[192:207]
	ds_read_b64_tr_b16 a[216:217], v10 offset:16384
	v_mfma_f32_32x32x16_bf16 v[224:239], a[196:199], v[40:43], v[224:239]
	ds_read_b64_tr_b16 a[218:219], v10 offset:16896
	v_mfma_f32_32x32x16_bf16 v[208:223], a[192:195], v[44:47], v[208:223]
	ds_read_b64_tr_b16 a[220:221], v11 offset:16384
	v_mfma_f32_32x32x16_bf16 v[240:255], a[196:199], v[44:47], v[240:255]
	ds_read_b64_tr_b16 a[222:223], v11 offset:16896
	s_waitcnt vmcnt(4)
	s_waitcnt lgkmcnt(8)
	v_mfma_f32_32x32x16_bf16 v[192:207], a[200:203], v[48:51], v[192:207]
	v_mfma_f32_32x32x16_bf16 v[224:239], a[204:207], v[48:51], v[224:239]
	v_mfma_f32_32x32x16_bf16 v[208:223], a[200:203], v[52:55], v[208:223]
	v_mfma_f32_32x32x16_bf16 v[240:255], a[204:207], v[52:55], v[240:255]
	s_waitcnt vmcnt(2)
	s_waitcnt lgkmcnt(4)
	v_mfma_f32_32x32x16_bf16 v[192:207], a[208:211], v[56:59], v[192:207]
	v_mfma_f32_32x32x16_bf16 v[224:239], a[212:215], v[56:59], v[224:239]
	v_mfma_f32_32x32x16_bf16 v[208:223], a[208:211], v[60:63], v[208:223]
	v_mfma_f32_32x32x16_bf16 v[240:255], a[212:215], v[60:63], v[240:255]
	s_waitcnt vmcnt(0)
	s_waitcnt lgkmcnt(0)
	v_mfma_f32_32x32x16_bf16 v[192:207], a[216:219], v[64:67], v[192:207]
	v_mfma_f32_32x32x16_bf16 v[224:239], a[220:223], v[64:67], v[224:239]
	v_mfma_f32_32x32x16_bf16 v[208:223], a[216:219], v[68:71], v[208:223]
	v_mfma_f32_32x32x16_bf16 v[240:255], a[220:223], v[68:71], v[240:255]
	s_waitcnt lgkmcnt(0)
	s_barrier
	s_nop 3
	s_lshl_b32 s55, s52, 12
	v_add_u32 v8, s55, v2
	v_add_u32 v9, 32768, v8
	s_cmp_eq_u32 s52, 0
	s_cbranch_scc1 L_r4w_46
	ds_write_b128 v8, v[192:195] offset:0
	ds_write_b128 v8, v[196:199] offset:1024
	ds_write_b128 v8, v[200:203] offset:2048
	ds_write_b128 v8, v[204:207] offset:3072
L_r4w_46:
	s_cmp_eq_u32 s52, 1
	s_cbranch_scc1 L_r4w_47
	ds_write_b128 v8, v[208:211] offset:16384
	ds_write_b128 v8, v[212:215] offset:17408
	ds_write_b128 v8, v[216:219] offset:18432
	ds_write_b128 v8, v[220:223] offset:19456
L_r4w_47:
	s_cmp_eq_u32 s52, 2
	s_cbranch_scc1 L_r4w_48
	ds_write_b128 v9, v[224:227] offset:0
	ds_write_b128 v9, v[228:231] offset:1024
	ds_write_b128 v9, v[232:235] offset:2048
	ds_write_b128 v9, v[236:239] offset:3072
L_r4w_48:
	s_cmp_eq_u32 s52, 3
	s_cbranch_scc1 L_r4w_49
	ds_write_b128 v9, v[240:243] offset:16384
	ds_write_b128 v9, v[244:247] offset:17408
	ds_write_b128 v9, v[248:251] offset:18432
	ds_write_b128 v9, v[252:255] offset:19456
L_r4w_49:
	s_waitcnt lgkmcnt(0)
	s_barrier
	s_lshl_b32 s55, s52, 14
	v_add_u32 v8, s55, v2
	s_add_u32 s56, s52, 1
	s_and_b32 s56, s56, 3
	s_lshl_b32 s56, s56, 12
	v_add_u32 v9, s56, v8
	ds_read_b128 v[32:35], v9 offset:0
	ds_read_b128 v[36:39], v9 offset:1024
	ds_read_b128 v[40:43], v9 offset:2048
	ds_read_b128 v[44:47], v9 offset:3072
	s_add_u32 s56, s52, 2
	s_and_b32 s56, s56, 3
	s_lshl_b32 s56, s56, 12
	v_add_u32 v9, s56, v8
	ds_read_b128 v[48:51], v9 offset:0
	ds_read_b128 v[52:55], v9 offset:1024
	ds_read_b128 v[56:59], v9 offset:2048
	ds_read_b128 v[60:63], v9 offset:3072
	s_add_u32 s56, s52, 3
	s_and_b32 s56, s56, 3
	s_lshl_b32 s56, s56, 12
	v_add_u32 v9, s56, v8
	ds_read_b128 v[64:67], v9 offset:0
	ds_read_b128 v[68:71], v9 offset:1024
	ds_read_b128 v[72:75], v9 offset:2048
	ds_read_b128 v[76:79], v9 offset:3072
	s_cmp_eq_u32 s52, 0
	s_cbranch_scc0 L_r4m_50
	v_pk_mul_f32 v[16:17], v[192:193], 1.0 op_sel_hi:[1,0]
	v_pk_mul_f32 v[18:19], v[194:195], 1.0 op_sel_hi:[1,0]
	v_pk_mul_f32 v[20:21], v[196:197], 1.0 op_sel_hi:[1,0]
	v_pk_mul_f32 v[22:23], v[198:199], 1.0 op_sel_hi:[1,0]
	v_pk_mul_f32 v[24:25], v[200:201], 1.0 op_sel_hi:[1,0]
	v_pk_mul_f32 v[26:27], v[202:203], 1.0 op_sel_hi:[1,0]
	v_pk_mul_f32 v[28:29], v[204:205], 1.0 op_sel_hi:[1,0]
	v_pk_mul_f32 v[30:31], v[206:207], 1.0 op_sel_hi:[1,0]
L_r4m_50:
	s_cmp_eq_u32 s52, 1
	s_cbranch_scc0 L_r4m_51
	v_pk_mul_f32 v[16:17], v[208:209], 1.0 op_sel_hi:[1,0]
	v_pk_mul_f32 v[18:19], v[210:211], 1.0 op_sel_hi:[1,0]
	v_pk_mul_f32 v[20:21], v[212:213], 1.0 op_sel_hi:[1,0]
	v_pk_mul_f32 v[22:23], v[214:215], 1.0 op_sel_hi:[1,0]
	v_pk_mul_f32 v[24:25], v[216:217], 1.0 op_sel_hi:[1,0]
	v_pk_mul_f32 v[26:27], v[218:219], 1.0 op_sel_hi:[1,0]
	v_pk_mul_f32 v[28:29], v[220:221], 1.0 op_sel_hi:[1,0]
	v_pk_mul_f32 v[30:31], v[222:223], 1.0 op_sel_hi:[1,0]
L_r4m_51:
	s_cmp_eq_u32 s52, 2
	s_cbranch_scc0 L_r4m_52
	v_pk_mul_f32 v[16:17], v[224:225], 1.0 op_sel_hi:[1,0]
	v_pk_mul_f32 v[18:19], v[226:227], 1.0 op_sel_hi:[1,0]
	v_pk_mul_f32 v[20:21], v[228:229], 1.0 op_sel_hi:[1,0]
	v_pk_mul_f32 v[22:23], v[230:231], 1.0 op_sel_hi:[1,0]
	v_pk_mul_f32 v[24:25], v[232:233], 1.0 op_sel_hi:[1,0]
	v_pk_mul_f32 v[26:27], v[234:235], 1.0 op_sel_hi:[1,0]
	v_pk_mul_f32 v[28:29], v[236:237], 1.0 op_sel_hi:[1,0]
	v_pk_mul_f32 v[30:31], v[238:239], 1.0 op_sel_hi:[1,0]
L_r4m_52:
	s_cmp_eq_u32 s52, 3
	s_cbranch_scc0 L_r4m_53
	v_pk_mul_f32 v[16:17], v[240:241], 1.0 op_sel_hi:[1,0]
	v_pk_mul_f32 v[18:19], v[242:243], 1.0 op_sel_hi:[1,0]
	v_pk_mul_f32 v[20:21], v[244:245], 1.0 op_sel_hi:[1,0]
	v_pk_mul_f32 v[22:23], v[246:247], 1.0 op_sel_hi:[1,0]
	v_pk_mul_f32 v[24:25], v[248:249], 1.0 op_sel_hi:[1,0]
	v_pk_mul_f32 v[26:27], v[250:251], 1.0 op_sel_hi:[1,0]
	v_pk_mul_f32 v[28:29], v[252:253], 1.0 op_sel_hi:[1,0]
	v_pk_mul_f32 v[30:31], v[254:255], 1.0 op_sel_hi:[1,0]
L_r4m_53:
	s_waitcnt lgkmcnt(0)
	v_pk_add_f32 v[16:17], v[16:17], v[32:33]
	v_pk_add_f32 v[18:19], v[18:19], v[34:35]
	v_pk_add_f32 v[20:21], v[20:21], v[36:37]
	v_pk_add_f32 v[22:23], v[22:23], v[38:39]
	v_pk_add_f32 v[24:25], v[24:25], v[40:41]
	v_pk_add_f32 v[26:27], v[26:27], v[42:43]
	v_pk_add_f32 v[28:29], v[28:29], v[44:45]
	v_pk_add_f32 v[30:31], v[30:31], v[46:47]
	v_pk_add_f32 v[16:17], v[16:17], v[48:49]
	v_pk_add_f32 v[18:19], v[18:19], v[50:51]
	v_pk_add_f32 v[20:21], v[20:21], v[52:53]
	v_pk_add_f32 v[22:23], v[22:23], v[54:55]
	v_pk_add_f32 v[24:25], v[24:25], v[56:57]
	v_pk_add_f32 v[26:27], v[26:27], v[58:59]
	v_pk_add_f32 v[28:29], v[28:29], v[60:61]
	v_pk_add_f32 v[30:31], v[30:31], v[62:63]
	v_pk_add_f32 v[16:17], v[16:17], v[64:65]
	v_pk_add_f32 v[18:19], v[18:19], v[66:67]
	v_pk_add_f32 v[20:21], v[20:21], v[68:69]
	v_pk_add_f32 v[22:23], v[22:23], v[70:71]
	v_pk_add_f32 v[24:25], v[24:25], v[72:73]
	v_pk_add_f32 v[26:27], v[26:27], v[74:75]
	v_pk_add_f32 v[28:29], v[28:29], v[76:77]
	v_pk_add_f32 v[30:31], v[30:31], v[78:79]
	v_fmac_f32 v128, v112, v16
	v_fmac_f32 v129, v113, v17
	v_fmac_f32 v130, v114, v18
	v_fmac_f32 v131, v115, v19
	v_fmac_f32 v132, v116, v20
	v_fmac_f32 v133, v117, v21
	v_fmac_f32 v134, v118, v22
	v_fmac_f32 v135, v119, v23
	v_fmac_f32 v136, v120, v24
	v_fmac_f32 v137, v121, v25
	v_fmac_f32 v138, v122, v26
	v_fmac_f32 v139, v123, v27
	v_fmac_f32 v140, v124, v28
	v_fmac_f32 v141, v125, v29
	v_fmac_f32 v142, v126, v30
	v_fmac_f32 v143, v127, v31
	v_cvt_pk_bf16_f32 v88, v128, v129
	v_cvt_pk_bf16_f32 v89, v130, v131
	v_cvt_pk_bf16_f32 v90, v132, v133
	v_cvt_pk_bf16_f32 v91, v134, v135
	v_cvt_pk_bf16_f32 v92, v136, v137
	v_cvt_pk_bf16_f32 v93, v138, v139
	v_cvt_pk_bf16_f32 v94, v140, v141
	v_cvt_pk_bf16_f32 v95, v142, v143
	v_and_b32 v8, 31, v1
	v_lshlrev_b32 v8, 10, v8
	v_lshrrev_b32 v9, 5, v1
	v_lshl_add_u32 v8, v9, 5, v8
	s_lshl_b32 s55, s98, 15
	s_lshl_b32 s56, s99, 6
	s_add_u32 s55, s55, s56
	v_add_u32 v8, s55, v8
	buffer_store_dwordx4 v[88:91], v8, s[40:43], 0 offen
	buffer_store_dwordx4 v[92:95], v8, s[40:43], 0 offen offset:16
L_end:
	s_endpgm
.section .rodata,"a"
.p2align 6
.amdhsa_kernel adaLN_cond__linear_kernel_hedgehog__glu_gated_reglu__prompt_kernel
  .amdhsa_next_free_vgpr 512
  .amdhsa_next_free_sgpr 102
  .amdhsa_accum_offset 256
  .amdhsa_group_segment_fixed_size 0
  .amdhsa_kernarg_size 104
  .amdhsa_user_sgpr_count 2
  .amdhsa_user_sgpr_kernarg_segment_ptr 1
  .amdhsa_system_sgpr_workgroup_id_x 1
.end_amdhsa_kernel
```
